```python
import torch

def _softmax(x, axis=-1):
    return torch.softmax(x, dim=axis)
def _gelu(x):
    return torch.nn.functional.gelu(x, approximate="tanh")
def _silu(x):
    return torch.nn.functional.silu(x)
def _sigmoid(x):
    return torch.sigmoid(x)
def _layernorm(x, axis=-1, eps=1e-5):
    m = x.mean(dim=axis, keepdim=True)
    v = x.var(dim=axis, keepdim=True, unbiased=False)
    return (x - m) / torch.sqrt(v + eps)
def _scatter_add(tgt, idx, src, axis=0):
    return tgt.clone().index_add_(axis, idx, src)
def _segment_sum(src, seg, n):
    out = torch.zeros((n,) + src.shape[1:], dtype=src.dtype)
    return out.index_add_(0, seg, src)
def _pad(x, pw):
    flat = tuple(v for pair in reversed(pw) for v in pair)
    return torch.nn.functional.pad(x, flat)

kernel_name = 'interleave_layers__sliding_block_cached__glu_gated_glu__decode'

def setup_inputs():

    _w = (lambda a: (lambda t: t.to(torch.bfloat16) if t.is_floating_point() else t)(torch.as_tensor(a)))
    def _A_setup():
        B, Sq, D = 8, 1, 512
        Hq, Hkv, Sk, Dh = 32, 8, 8192, 128
        assert Hq % Hkv == 0, (Hq, Hkv)
        return {
            "x": _w((lambda *s: torch.randn(*s, dtype=torch.bfloat16) * 0.05)(B, Sq, D)),
            "k_cache": _w((lambda *s: torch.randn(*s, dtype=torch.bfloat16) * 1.6)(B, Hkv, Sk, Dh)),
            "v_cache": _w((lambda *s: torch.randn(*s, dtype=torch.bfloat16) * 1.6)(B, Hkv, Sk, Dh)),
            "wq": _w((lambda *s: torch.randn(*s, dtype=torch.bfloat16) * 1.6)(D, Hq * Dh) * (D ** -0.5)),
            "wo": _w((lambda *s: torch.randn(*s, dtype=torch.bfloat16) * 1.6)(Hq * Dh, D) * ((Hq * Dh) ** -0.5)),
        }
    _A_in = _A_setup()

    def _B_setup():
        B, S, D, F = 8, 1, 512, 1792
        return {
            "x": _w((lambda *s: torch.randn(*s, dtype=torch.bfloat16) * 0.05)(B, S, D)),
            "w_gate": _w((lambda *s: torch.randn(*s, dtype=torch.bfloat16) * 0.05)(D, F)),
            "w_up": _w((lambda *s: torch.randn(*s, dtype=torch.bfloat16) * 0.05)(D, F)),
            "w_down": _w((lambda *s: torch.randn(*s, dtype=torch.bfloat16) * 0.05)(F, D)),
        }
    _B_in = _B_setup()

    return {
        "A_x": _A_in["x"],
        "A_k_cache": _A_in["k_cache"],
        "A_v_cache": _A_in["v_cache"],
        "A_wq": _A_in["wq"],
        "A_wo": _A_in["wo"],
        "B_x": _B_in["x"],
        "B_w_gate": _B_in["w_gate"],
        "B_w_up": _B_in["w_up"],
        "B_w_down": _B_in["w_down"],
    }

def reference(A_x, A_k_cache, A_v_cache, A_wq, A_wo, B_x, B_w_gate, B_w_up, B_w_down):
    def _A_ref(x, k_cache, v_cache, wq, wo):
        B, Sq, D = x.shape
        Hq, Dh = 32, 128
        Hkv, Sk = k_cache.shape[1], k_cache.shape[2]
        W = min(4096, max(256, Sk // 4))
        rep = Hq // Hkv
        q = (lambda x, *d: x.permute(*d))((x @ wq).reshape(B, Sq, Hq, Dh), 0, 2, 1, 3)
        k = (lambda x, n, axis: torch.repeat_interleave(x, n, dim=axis))(k_cache[:, :, Sk - W:, :], rep, axis=1)
        v = (lambda x, n, axis: torch.repeat_interleave(x, n, dim=axis))(v_cache[:, :, Sk - W:, :], rep, axis=1)
        scores = torch.einsum("bhqd,bhkd->bhqk", q, k) * (Dh ** -0.5)
        p = _softmax(scores, axis=-1)
        o = torch.einsum("bhqk,bhkd->bhqd", p, v)
        return (lambda x, *d: x.permute(*d))(o, 0, 2, 1, 3).reshape(B, Sq, Hq * Dh) @ wo

    def _B_ref(x, w_gate, w_up, w_down):
        g = torch.einsum("bsd,df->bsf", x, w_gate)
        u = torch.einsum("bsd,df->bsf", x, w_up)
        h = _sigmoid(g) * u
        return torch.einsum("bsf,fd->bsd", h, w_down)

    x = A_x
    x = x + _A_ref(_layernorm(x, axis=-1), A_k_cache, A_v_cache, A_wq, A_wo)
    x = x + _B_ref(_layernorm(x, axis=-1), B_w_gate, B_w_up, B_w_down)
    x = x + _A_ref(_layernorm(x, axis=-1), A_k_cache, A_v_cache, A_wq, A_wo)
    x = x + _B_ref(_layernorm(x, axis=-1), B_w_gate, B_w_up, B_w_down)
    return x
```

```asm
; @launch grid=(256,1,1) block=(256,1,1) lds=163840
.amdgcn_target "amdgcn-amd-amdhsa--gfx950"
.text
.globl interleave_layers__sliding_block_cached__glu_gated_glu__decode_kernel
.p2align 8
.type interleave_layers__sliding_block_cached__glu_gated_glu__decode_kernel,@function
interleave_layers__sliding_block_cached__glu_gated_glu__decode_kernel:
    s_cmp_ge_u32 s2, 256
    s_cbranch_scc1 L_end
    s_load_dwordx16 s[64:79], s[0:1], 0
    s_load_dwordx8 s[80:87], s[0:1], 64
    s_and_b32 s20, s2, 7
    s_lshr_b32 s21, s2, 3
    s_lshr_b32 s22, s21, 2
    s_and_b32 s23, s21, 3
    v_lshrrev_b32 v28, 6, v0
    v_and_b32 v1, 63, v0
    v_readfirstlane_b32 s24, v28
    v_and_b32 v2, 15, v1
    v_lshrrev_b32 v3, 4, v1
    s_mov_b32 s25, 0
    s_mov_b32 s26, 0
    s_mov_b32 s27, 200000
    s_mov_b32 s35, 3
    s_sub_u32 s41, s21, 23
    s_cmp_lt_u32 s21, 31
    s_cselect_b32 s35, 2, s35
    s_cmp_lt_u32 s21, 23
    s_cselect_b32 s35, 1, s35
    s_cbranch_scc0 L_role1
    s_sub_u32 s41, s21, 16
L_role1:
    s_cmp_lt_u32 s21, 16
    s_cselect_b32 s35, 0, s35
    s_cbranch_scc0 L_role2
    s_lshr_b32 s41, s21, 1
L_role2:
    s_mov_b32 s50, 0x00ff00ff
    s_mov_b32 s51, 0x00ff00ff
    s_mov_b32 s54, 0xffffffff
    s_mov_b32 s55, 0x00000000
    s_mov_b32 s62, 0xffffffff
    s_mov_b32 s63, 0x0000ffff
    s_waitcnt lgkmcnt(0)
    s_mov_b64 s[0:1], -1
    s_lshl_b32 s30, s24, 15
    v_xor_b32 v30, v2, v3
    v_lshlrev_b32 v30, 4, v30
    v_lshl_add_u32 v30, v3, 8, v30
    v_add_u32 v88, s30, v30
    v_xor_b32 v89, 64, v88
    v_xor_b32 v90, 0x80, v88
    v_xor_b32 v91, 0xc0, v88
    v_lshlrev_b32 v0, 11, v3
    v_lshl_add_u32 v0, v2, 4, v0
    v_add_u32 v0, s30, v0
    s_mul_i32 s101, s24, 12288
    s_add_u32 s101, s101, 98304
    s_lshl_b32 s30, s22, 3
    s_add_u32 s30, s30, s20
    s_lshl_b32 s30, s30, 21
    s_lshl_b32 s31, s23, 17
    s_add_u32 s30, s30, s31
    s_add_u32 s30, s30, 1572864
    s_add_u32 s8, s66, s30
    s_addc_u32 s9, s67, 0
    s_mov_b32 s10, 0x20000
    s_mov_b32 s11, 0x00020000
    s_add_u32 s12, s68, s30
    s_addc_u32 s13, s69, 0
    s_mov_b32 s14, 0x20000
    s_mov_b32 s15, 0x00020000
    s_mov_b32 s30, s23
    s_and_b32 s30, s30, 3
    s_lshl_b32 s98, s30, 13
    s_mov_b32 s30, s24
    s_and_b32 s30, s30, 3
    s_lshl_b32 s30, s30, 11
    s_mov_b32 s99, s98
    s_or_b32 s98, s98, s30
    v_xor_b32 v0, s30, v0
    s_mov_b32 s30, 0
    s_and_b32 s30, s30, 1
    s_lshl_b32 s30, s30, 10
    s_or_b32 s98, s98, s30
    s_or_b32 s99, s99, s30
    v_and_b32 v30, 3, v2
    v_xor_b32 v30, v30, v3
    v_lshlrev_b32 v64, 8, v2
    v_lshl_add_u32 v64, v30, 4, v64
    v_lshrrev_b32 v30, 2, v2
    v_lshl_add_u32 v64, v30, 6, v64
    v_add_u32 v64, s101, v64
    v_xor_b32 v65, 64, v64
    v_xor_b32 v66, 128, v64
    v_xor_b32 v67, 192, v64
    s_add_u32 m0, s101, 0
    s_xor_b32 s96, s98, 0
    buffer_load_dwordx4 v88, s[8:11], s96 offen nt lds
    s_add_u32 m0, s101, 1024
    s_xor_b32 s96, s98, 2048
    buffer_load_dwordx4 v89, s[8:11], s96 offen nt lds
    s_add_u32 m0, s101, 2048
    s_xor_b32 s96, s98, 4096
    buffer_load_dwordx4 v90, s[8:11], s96 offen nt lds
    s_add_u32 m0, s101, 3072
    s_xor_b32 s96, s98, 6144
    buffer_load_dwordx4 v91, s[8:11], s96 offen nt lds
    s_add_u32 m0, s101, 4096
    s_xor_b32 s96, s98, 8192
    buffer_load_dwordx4 v88, s[8:11], s96 offen nt lds
    s_mov_b32 s92, s64
    s_mov_b32 s93, s65
    s_mov_b32 s94, 0x2000
    s_mov_b32 s95, 0x00020000
    v_lshlrev_b32 v28, 4, v1
    s_lshl_b32 s29, s24, 11
    s_add_u32 m0, s29, 12288
    s_nop 0
    buffer_load_dwordx4 v28, s[92:95], s29 offen lds
    s_add_u32 s29, s29, 1024
    s_add_u32 m0, s29, 12288
    s_nop 0
    buffer_load_dwordx4 v28, s[92:95], s29 offen lds
    v_bfe_u32 v28, v1, 1, 3
    v_lshlrev_b32 v22, 10, v28
    v_bfe_u32 v28, v1, 4, 1
    v_lshl_add_u32 v22, v28, 4, v22
    v_and_b32 v28, 1, v1
    v_lshl_add_u32 v22, v28, 3, v22
    s_lshl_b32 s29, s21, 5
    v_add_u32 v22, s29, v22
    s_mov_b32 s4, s86
    s_mov_b32 s5, s87
    s_mov_b32 s6, 0x200000
    s_mov_b32 s7, 0x00020000
    s_cmp_lg_u32 s24, 0
    s_cbranch_scc1 L_w0skip_1
    s_mov_b64 exec, s[54:55]
    buffer_load_dwordx2 v[26:27], v22, s[92:95], 0 offen
    s_mov_b64 exec, -1
L_w0skip_1:
    v_mov_b32 v96, -1
    v_mov_b32 v97, -1
    v_mov_b32 v98, -1
    v_mov_b32 v99, -1
    s_mov_b32 s96, 0
    s_cmp_eq_u32 s24, 1
    s_cbranch_scc1 L_c1_2
    s_cmp_eq_u32 s24, 2
    s_cbranch_scc1 L_c2_3
    s_cmp_eq_u32 s24, 3
    s_cbranch_scc1 L_c3_4
    v_lshlrev_b32 v28, 4, v2
    s_lshl_b32 s29, s21, 8
    s_lshl_b32 s30, s20, 13
    s_add_u32 s29, s29, s30
    v_add_u32 v28, s29, v28
    v_lshl_add_u32 v30, v3, 16, v28
    s_mov_b64 exec, s[62:63]
    s_mov_b32 s30, 983040
    buffer_store_dwordx4 v[96:99], v30, s[4:7], s30 offen sc1
    s_mov_b64 exec, s[54:55]
    s_mov_b32 s30, 0
    buffer_store_dwordx4 v[96:99], v30, s[4:7], s30 offen sc1
    s_mov_b64 exec, 1
    s_getreg_b32 s29, hwreg(HW_REG_XCC_ID, 0, 4)
    s_lshl_b32 s30, s2, 2
    v_mov_b32 v28, s30
    v_mov_b32 v29, s29
    s_mov_b32 s30, 1507328
    buffer_store_dword v29, v28, s[4:7], s30 offen sc1
    s_branch L_cd_5
L_c1_2:
    s_lshl_b32 s29, s21, 10
    s_lshl_b32 s30, s20, 15
    s_add_u32 s29, s29, s30
    v_lshlrev_b32 v28, 4, v1
    v_add_u32 v28, s29, v28
    s_mov_b32 s30, 131072
    buffer_store_dwordx4 v[96:99], v28, s[4:7], s30 offen sc1
    s_mov_b32 s30, 393216
    buffer_store_dwordx4 v[96:99], v28, s[4:7], s30 offen sc1
    s_branch L_cd_5
L_c2_3:
    s_lshl_b32 s29, s21, 5
    s_lshl_b32 s30, s20, 10
    s_add_u32 s29, s29, s30
    v_lshrrev_b32 v28, 1, v1
    v_lshlrev_b32 v28, 13, v28
    v_and_b32 v29, 1, v1
    v_lshl_add_u32 v28, v29, 4, v28
    v_add_u32 v28, s29, v28
    s_mov_b64 exec, 0xf
    s_mov_b32 s30, 655360
    buffer_store_dwordx4 v[96:99], v28, s[4:7], s30 offen sc1
    s_mov_b64 exec, -1
    s_cmp_eq_u32 s35, 0
    s_cbranch_scc1 L_rco_6
    s_cmp_eq_u32 s35, 2
    s_cbranch_scc1 L_rcd_8
    v_lshrrev_b32 v28, 5, v1
    v_lshlrev_b32 v28, 15, v28
    v_and_b32 v29, 31, v1
    v_lshl_add_u32 v28, v29, 4, v28
    s_min_u32 s29, s41, 7
    s_lshl_b32 s29, s29, 9
    s_lshl_b32 s30, s20, 12
    s_add_u32 s29, s29, s30
    v_add_u32 v28, s29, v28
    s_mov_b32 s30, 1179648
    buffer_store_dwordx4 v[96:99], v28, s[4:7], s30 offen sc1
    s_branch L_rcj_9
L_rco_6:
    v_lshlrev_b32 v28, 12, v3
    v_bfe_u32 v29, v1, 3, 1
    v_lshl_add_u32 v28, v29, 8, v28
    v_and_b32 v29, 7, v1
    v_lshl_add_u32 v28, v29, 4, v28
    s_lshl_b32 s29, s41, 14
    s_lshl_b32 s30, s20, 9
    s_add_u32 s29, s29, s30
    s_and_b32 s30, s21, 1
    s_lshl_b32 s30, s30, 7
    s_add_u32 s29, s29, s30
    v_add_u32 v28, s29, v28
    s_mov_b32 s30, 720896
    buffer_store_dwordx4 v[96:99], v28, s[4:7], s30 offen sc1
    s_branch L_rcj_9
L_rcd_8:
L_rcj_9:
    s_cmp_eq_u32 s35, 1
    s_cbranch_scc1 L_ncue_10
    s_cmp_eq_u32 s35, 3
    s_cbranch_scc1 L_ncue_10
    s_cmp_eq_u32 s35, 2
    s_cselect_b32 s29, 0x2000, 0
    s_lshl_b32 s30, s20, 10
    s_add_u32 s29, s29, s30
    s_lshl_b32 s30, s41, 7
    s_add_u32 s29, s29, s30
    v_lshlrev_b32 v28, 14, v1
    v_add_u32 v28, s29, v28
    s_mov_b64 exec, 3
    s_mov_b32 s30, 1511424
    buffer_store_dword v96, v28, s[4:7], s30 offen sc1
    s_mov_b64 exec, -1
L_ncue_10:
    s_branch L_cd_5
L_c3_4:
    s_cmp_eq_u32 s35, 0
    s_cbranch_scc1 L_rco_11
    s_cmp_eq_u32 s35, 2
    s_cbranch_scc1 L_rcd_13
    v_lshrrev_b32 v28, 5, v1
    v_lshlrev_b32 v28, 15, v28
    v_and_b32 v29, 31, v1
    v_lshl_add_u32 v28, v29, 4, v28
    s_min_u32 s29, s41, 7
    s_lshl_b32 s29, s29, 9
    s_lshl_b32 s30, s20, 12
    s_add_u32 s29, s29, s30
    v_add_u32 v28, s29, v28
    s_mov_b32 s30, 1179648
    buffer_store_dwordx4 v[96:99], v28, s[4:7], s30 offen sc1
    s_branch L_rcj_14
L_rco_11:
    v_lshlrev_b32 v28, 12, v3
    v_bfe_u32 v29, v1, 3, 1
    v_lshl_add_u32 v28, v29, 8, v28
    v_and_b32 v29, 7, v1
    v_lshl_add_u32 v28, v29, 4, v28
    s_lshl_b32 s29, s41, 14
    s_lshl_b32 s30, s20, 9
    s_add_u32 s29, s29, s30
    s_and_b32 s30, s21, 1
    s_lshl_b32 s30, s30, 7
    s_add_u32 s29, s29, s30
    v_add_u32 v28, s29, v28
    s_mov_b32 s30, 851968
    buffer_store_dwordx4 v[96:99], v28, s[4:7], s30 offen sc1
    s_branch L_rcj_14
L_rcd_13:
L_rcj_14:
    s_cmp_eq_u32 s35, 0
    s_cbranch_scc1 L_rco_15
    s_cmp_eq_u32 s35, 2
    s_cbranch_scc1 L_rcd_17
    s_branch L_rcj_18
L_rco_15:
    s_branch L_rcj_18
L_rcd_17:
    v_lshrrev_b32 v28, 5, v1
    v_lshlrev_b32 v28, 12, v28
    v_and_b32 v29, 31, v1
    v_lshl_add_u32 v28, v29, 4, v28
    s_lshl_b32 s29, s41, 14
    s_lshl_b32 s30, s20, 9
    s_add_u32 s29, s29, s30
    v_add_u32 v28, s29, v28
    s_mov_b32 s30, 1245184
    buffer_store_dwordx4 v[96:99], v28, s[4:7], s30 offen sc1
    v_lshrrev_b32 v28, 5, v1
    v_lshlrev_b32 v28, 12, v28
    v_and_b32 v29, 31, v1
    v_lshl_add_u32 v28, v29, 4, v28
    s_lshl_b32 s29, s41, 14
    s_lshl_b32 s30, s20, 9
    s_add_u32 s29, s29, s30
    v_add_u32 v28, s29, v28
    s_mov_b32 s30, 1253376
    buffer_store_dwordx4 v[96:99], v28, s[4:7], s30 offen sc1
    v_lshrrev_b32 v28, 5, v1
    v_lshlrev_b32 v28, 12, v28
    v_and_b32 v29, 31, v1
    v_lshl_add_u32 v28, v29, 4, v28
    s_lshl_b32 s29, s41, 14
    s_lshl_b32 s30, s20, 9
    s_add_u32 s29, s29, s30
    v_add_u32 v28, s29, v28
    s_mov_b32 s30, 1376256
    buffer_store_dwordx4 v[96:99], v28, s[4:7], s30 offen sc1
    v_lshrrev_b32 v28, 5, v1
    v_lshlrev_b32 v28, 12, v28
    v_and_b32 v29, 31, v1
    v_lshl_add_u32 v28, v29, 4, v28
    s_lshl_b32 s29, s41, 14
    s_lshl_b32 s30, s20, 9
    s_add_u32 s29, s29, s30
    v_add_u32 v28, s29, v28
    s_mov_b32 s30, 1384448
    buffer_store_dwordx4 v[96:99], v28, s[4:7], s30 offen sc1
L_rcj_18:
L_cd_5:
    s_mov_b64 exec, -1
    v_lshrrev_b32 v28, 1, v1
    v_and_b32 v29, 1, v1
    s_lshl_b32 s29, s24, 7
    v_add_u32 v20, s29, v28
    v_lshlrev_b32 v20, 13, v20
    v_lshl_add_u32 v20, v29, 4, v20
    s_lshl_b32 s29, s20, 10
    s_lshl_b32 s30, s21, 5
    s_add_u32 s29, s29, s30
    v_add_u32 v20, s29, v20
    s_lshl_b32 s31, s24, 12
    s_mov_b32 s16, s70
    s_mov_b32 s17, s71
    s_mov_b32 s18, 0x400000
    s_mov_b32 s19, 0x00020000
    s_lshl_b32 s100, s24, 12
    s_add_u32 m0, s100, 147456
    s_mov_b32 s96, 0
    buffer_load_dwordx4 v20, s[16:19], s96 offen nt lds
    s_add_u32 m0, s100, 148480
    s_mov_b32 s96, 262144
    buffer_load_dwordx4 v20, s[16:19], s96 offen nt lds
    s_add_u32 m0, s100, 149504
    s_mov_b32 s96, 524288
    buffer_load_dwordx4 v20, s[16:19], s96 offen nt lds
    s_add_u32 m0, s100, 150528
    s_mov_b32 s96, 786432
    buffer_load_dwordx4 v20, s[16:19], s96 offen nt lds
    s_mov_b32 s42, 0x22222222
    s_mov_b32 s43, 0x00000000
    s_mov_b32 s44, 0x44444444
    s_mov_b32 s45, 0x00000000
    s_mov_b32 s46, 0x88888888
    s_mov_b32 s47, 0x00000000
    s_mov_b32 s48, 0x00f0000f
    s_mov_b32 s49, 0x000000ff
    s_mov_b32 s52, 0x000f000f
    s_mov_b32 s53, 0x000f000f
    s_mov_b32 s56, 0x55555555
    s_mov_b32 s57, 0x55555555
    s_mov_b32 s58, 0x0000ffff
    s_mov_b32 s59, 0x00000000
    s_mov_b32 s60, 0x0000000f
    s_mov_b32 s61, 0x00000000
    v_mov_b32 v4, 0
    v_mov_b32 v5, 0
    v_mov_b32 v9, 0
    v_mov_b32 v10, 0
    v_mov_b32 v11, 0
    v_mov_b32 v12, 0
    v_mov_b32 v23, 0
    v_mov_b32 v84, 0
    v_mov_b32 v85, 0
    v_mov_b32 v86, 0
    v_mov_b32 v87, 0
    v_mov_b32 v21, 0
    s_cmp_eq_u32 s35, 0
    s_cbranch_scc1 L_rao_19
    s_cmp_eq_u32 s35, 2
    s_cbranch_scc0 L_rag_20
    v_lshlrev_b32 v28, 7, v3
    v_lshl_add_u32 v28, v2, 4, v28
    s_lshl_b32 s29, s24, 10
    v_add_u32 v4, s29, v28
    s_lshl_b32 s29, s24, 11
    v_add_u32 v5, s29, v28
    v_bfe_u32 v28, v1, 4, 1
    v_lshlrev_b32 v23, 5, v28
    v_lshlrev_b32 v12, 4, v28
    v_and_b32 v28, 1, v1
    v_lshl_add_u32 v23, v28, 4, v23
    v_lshl_add_u32 v12, v28, 3, v12
    s_lshl_b32 s29, s24, 6
    v_add_u32 v23, s29, v23
    v_bfe_u32 v28, v1, 1, 3
    v_mul_u32_u24 v9, 272, v28
    v_add_u32 v9, v9, v23
    v_lshlrev_b32 v10, 5, v28
    v_lshl_add_u32 v12, v28, 7, v12
    s_lshl_b32 s29, s41, 10
    s_lshl_b32 s30, s24, 5
    s_add_u32 s29, s29, s30
    v_add_u32 v12, s29, v12
    v_and_b32 v28, 31, v1
    v_lshlrev_b32 v11, 4, v28
    s_lshl_b32 s29, s41, 2
    s_add_u32 s29, s29, s24
    s_lshl_b32 s29, s29, 12
    s_lshl_b32 s30, s20, 9
    s_add_u32 s29, s29, s30
    v_add_u32 v11, s29, v11
    s_branch L_raj_21
L_rag_20:
    v_lshlrev_b32 v28, 7, v3
    v_lshl_add_u32 v28, v2, 4, v28
    s_lshl_b32 s29, s24, 11
    v_add_u32 v4, s29, v28
    v_and_b32 v28, 7, v1
    v_lshlrev_b32 v23, 2, v28
    v_lshlrev_b32 v11, 1, v28
    s_lshl_b32 s29, s24, 5
    v_add_u32 v23, s29, v23
    v_lshrrev_b32 v28, 3, v1
    v_mul_u32_u24 v9, 272, v28
    v_add_u32 v9, v9, v23
    v_lshlrev_b32 v10, 5, v28
    v_lshl_add_u32 v11, v28, 4, v11
    s_lshl_b32 s29, s41, 9
    s_lshl_b32 s30, s24, 7
    s_add_u32 s29, s29, s30
    v_add_u32 v11, s29, v11
    s_branch L_raj_21
L_rao_19:
    s_and_b32 s30, s21, 1
    s_lshl_b32 s29, s30, 14
    s_lshl_b32 s31, s24, 12
    s_add_u32 s29, s29, s31
    v_lshlrev_b32 v4, 4, v1
    v_add_u32 v4, s29, v4
    s_lshl_b32 s29, s30, 9
    s_lshl_b32 s31, s24, 7
    s_add_u32 s29, s29, s31
    v_and_b32 v28, 3, v2
    v_lshl_add_u32 v28, v3, 2, v28
    v_lshlrev_b32 v5, 3, v28
    v_add_u32 v5, s29, v5
    s_lshl_b32 s30, s30, 4
    v_bfe_u32 v28, v1, 3, 1
    v_lshlrev_b32 v9, 5, v28
    v_lshlrev_b32 v11, 8, v28
    v_and_b32 v28, 1, v1
    v_lshl_add_u32 v9, v28, 4, v9
    v_lshl_add_u32 v11, v28, 4, v11
    v_bfe_u32 v28, v1, 1, 2
    v_mul_u32_u24 v29, 272, v28
    v_add_u32 v9, v9, v29
    s_lshl_b32 s29, s24, 6
    v_add_u32 v9, s29, v9
    s_lshr_b32 s30, s30, 2
    v_add_u32 v28, s30, v28
    v_lshl_add_u32 v11, v28, 5, v11
    s_lshl_b32 s29, s41, 2
    s_add_u32 s29, s29, s24
    s_lshl_b32 s29, s29, 12
    s_lshl_b32 s30, s20, 9
    s_add_u32 s29, s29, s30
    v_add_u32 v11, s29, v11
L_raj_21:
    v_and_b32 v28, 31, v1
    s_lshl_b32 s29, s21, 8
    v_lshlrev_b32 v7, 3, v28
    v_add_u32 v7, s29, v7
    v_bfe_u32 v28, v1, 1, 3
    v_lshlrev_b32 v93, 5, v28
    v_mul_u32_u24 v94, 272, v28
    v_lshlrev_b32 v95, 5, v28
    v_bfe_u32 v28, v1, 4, 1
    v_lshl_add_u32 v93, v28, 4, v93
    v_lshl_add_u32 v94, v28, 5, v94
    v_and_b32 v28, 1, v1
    v_lshl_add_u32 v93, v28, 3, v93
    v_lshl_add_u32 v94, v28, 4, v94
    v_add_u32 v93, s29, v93
    v_lshlrev_b32 v92, 7, v3
    v_lshl_add_u32 v92, v2, 4, v92
    s_lshl_b32 s29, s24, 11
    v_add_u32 v92, s29, v92
    v_lshlrev_b32 v16, 5, v2
    s_lshl_b32 s29, s24, 3
    v_add_u32 v16, s29, v16
    v_lshrrev_b32 v28, 5, v1
    v_and_b32 v29, 31, v1
    v_lshlrev_b32 v6, 9, v28
    v_lshl_add_u32 v6, v29, 4, v6
    s_lshr_b32 s29, s21, 4
    s_lshl_b32 s29, s29, 14
    s_lshl_b32 s30, s24, 12
    s_add_u32 s29, s29, s30
    s_and_b32 s30, s21, 15
    s_lshl_b32 s30, s30, 4
    s_add_u32 s29, s29, s30
    v_lshrrev_b32 v28, 2, v1
    v_lshlrev_b32 v8, 8, v28
    v_and_b32 v28, 3, v1
    v_lshl_add_u32 v8, v28, 2, v8
    v_add_u32 v8, s29, v8
    s_mul_i32 s29, s24, 2560
    v_mul_u32_u24 v13, 1088, v3
    v_lshl_add_u32 v13, v2, 2, v13
    v_add_u32 v13, s29, v13
    v_mul_u32_u24 v14, 272, v3
    v_lshl_add_u32 v14, v2, 2, v14
    v_add_u32 v14, s29, v14
    v_lshlrev_b32 v15, 5, v2
    v_cmp_gt_u32 vcc, 2, v3
    v_add_u32 v28, 16, v15
    s_nop 0
    v_cndmask_b32 v15, v15, v28, vcc
    s_lshl_b32 s29, s24, 2
    v_add_u32 v15, s29, v15
    v_mov_b32 v17, 0x3e0293ee
    s_mul_i32 s29, s24, 2176
    v_lshlrev_b32 v18, 4, v2
    v_lshl_add_u32 v18, v3, 6, v18
    v_add_u32 v18, s29, v18
    v_lshrrev_b32 v28, 1, v2
    v_mul_u32_u24 v19, 272, v28
    v_lshl_add_u32 v19, v3, 6, v19
    v_and_b32 v28, 1, v1
    v_lshl_add_u32 v19, v28, 3, v19
    s_lshl_b32 s29, s24, 4
    v_add_u32 v19, s29, v19
    s_lshl_b32 s29, s25, 18
    s_lshl_b32 s30, s20, 15
    s_add_u32 s33, s29, s30
    s_add_u32 s33, s33, 131072
    s_lshl_b32 s29, s25, 13
    s_lshl_b32 s30, s20, 10
    s_add_u32 s97, s29, s30
    s_add_u32 s97, s97, 655360
    s_lshl_b32 s29, s25, 17
    s_add_u32 s34, s29, 720896
    s_lshl_b32 s30, s21, 12
    s_add_u32 s29, s29, s30
    s_add_u32 s36, s29, 720896
    s_add_u32 s39, s29, 1245184
    s_lshl_b32 s29, s25, 17
    s_lshl_b32 s30, s20, 13
    s_add_u32 s37, s29, s30
    s_add_u32 s37, s37, 983040
    s_lshl_b32 s29, s25, 15
    s_lshl_b32 s30, s20, 12
    s_add_u32 s38, s29, s30
    s_add_u32 s38, s38, 1179648
    s_lshl_b32 s30, s20, 13
    s_add_u32 s32, s30, 0
    s_add_u32 s40, s30, 1048576
    s_cmp_eq_u32 s35, 1
    s_cbranch_scc1 L_cls_23
    s_cmp_eq_u32 s35, 0
    s_cbranch_scc1 L_cls_23
    s_add_u32 m0, s101, 5120
    s_xor_b32 s96, s98, 10240
    s_waitcnt vmcnt(10)
    buffer_load_dwordx4 v89, s[8:11], s96 offen nt lds
    s_add_u32 m0, s101, 6144
    s_xor_b32 s96, s98, 12288
    s_waitcnt vmcnt(10)
    buffer_load_dwordx4 v90, s[8:11], s96 offen nt lds
    s_add_u32 m0, s101, 7168
    s_xor_b32 s96, s98, 14336
    s_waitcnt vmcnt(10)
    buffer_load_dwordx4 v91, s[8:11], s96 offen nt lds
    s_waitcnt vmcnt(10)
    ds_read_b128 a[0:3], v64 offset:0
    ds_read_b128 a[4:7], v65 offset:0
    ds_read_b128 a[8:11], v66 offset:0
    ds_read_b128 a[12:15], v67 offset:0
    s_add_u32 m0, s101, 8192
    s_xor_b32 s96, s98, 16384
    s_waitcnt vmcnt(10)
    buffer_load_dwordx4 v88, s[8:11], s96 offen nt lds
    s_add_u32 m0, s101, 9216
    s_xor_b32 s96, s98, 18432
    s_waitcnt vmcnt(10)
    buffer_load_dwordx4 v89, s[8:11], s96 offen nt lds
    s_add_u32 m0, s101, 10240
    s_xor_b32 s96, s98, 20480
    s_waitcnt vmcnt(4)
    buffer_load_dwordx4 v90, s[8:11], s96 offen nt lds
    s_add_u32 m0, s101, 11264
    s_xor_b32 s96, s98, 22528
    s_waitcnt vmcnt(4)
    buffer_load_dwordx4 v91, s[8:11], s96 offen nt lds
    s_waitcnt vmcnt(4)
    ds_read_b128 a[16:19], v64 offset:4096
    ds_read_b128 a[20:23], v65 offset:4096
    ds_read_b128 a[24:27], v66 offset:4096
    ds_read_b128 a[28:31], v67 offset:4096
    s_waitcnt vmcnt(11)
    s_barrier
    s_cmp_lg_u32 s24, 0
    s_cbranch_scc1 L_w0skip_24
    s_and_b32 s29, s20, 3
    s_lshl_b32 s29, s29, 6
    s_lshr_b32 s30, s20, 2
    s_lshl_b32 s30, s30, 2
    s_add_u32 s29, s29, s30
    s_mov_b64 exec, 1
    v_mov_b32 v84, s29
    v_mov_b32 v85, 1
    global_atomic_add v84, v85, s[84:85]
    s_mov_b64 exec, -1
L_w0skip_24:
    s_cmp_lg_u32 s24, 0
    s_cbranch_scc1 L_w0skip_25
    v_lshlrev_b32 v24, 16, v26
    v_and_b32 v25, 0xffff0000, v26
    v_lshlrev_b32 v26, 16, v27
    v_and_b32 v27, 0xffff0000, v27
L_w0skip_25:
    s_waitcnt vmcnt(7)
    v_lshrrev_b32 v28, 2, v2
    v_lshl_add_u32 v28, v3, 3, v28
    s_lshl_b32 s30, s24, 7
    v_add_u32 v28, s30, v28
    v_lshlrev_b32 v28, 5, v28
    v_add_u32 v28, 147456, v28
    v_and_b32 v29, 3, v2
    v_lshl_add_u32 v28, v29, 3, v28
    ds_read_b64_tr_b16 a[236:237], v28 offset:0
    ds_read_b64_tr_b16 a[238:239], v28 offset:128
    ds_read_b64_tr_b16 a[240:241], v28 offset:1024
    ds_read_b64_tr_b16 a[242:243], v28 offset:1152
    ds_read_b64_tr_b16 a[244:245], v28 offset:2048
    ds_read_b64_tr_b16 a[246:247], v28 offset:2176
    ds_read_b64_tr_b16 a[248:249], v28 offset:3072
    ds_read_b64_tr_b16 a[250:251], v28 offset:3200
    v_mov_b32 v32, 0x3f803f80
    v_mov_b32 v33, 0x3f803f80
    v_mov_b32 v34, 0x3f803f80
    v_mov_b32 v35, 0x3f803f80
    v_mov_b32 v36, 0x3f803f80
    v_mov_b32 v37, 0x3f803f80
    v_mov_b32 v38, 0x3f803f80
    v_mov_b32 v39, 0x3f803f80
    v_mov_b32 v40, 0x3f803f80
    v_mov_b32 v41, 0x3f803f80
    v_mov_b32 v42, 0x3f803f80
    v_mov_b32 v43, 0x3f803f80
    v_mov_b32 v44, 0x3f803f80
    v_mov_b32 v45, 0x3f803f80
    v_mov_b32 v46, 0x3f803f80
    v_mov_b32 v47, 0x3f803f80
    v_lshlrev_b32 v30, 10, v2
    v_lshl_add_u32 v30, v3, 4, v30
    s_lshl_b32 s29, s24, 8
    s_add_u32 s29, s29, 12288
    v_add_u32 v30, s29, v30
    s_mov_b64 exec, s[50:51]
    ds_read_b128 v[32:35], v30 offset:0
    ds_read_b128 v[36:39], v30 offset:64
    ds_read_b128 v[40:43], v30 offset:128
    ds_read_b128 v[44:47], v30 offset:192
    s_mov_b64 exec, -1
    s_waitcnt lgkmcnt(0)
    s_add_u32 m0, s101, 0
    s_xor_b32 s96, s98, 24576
    s_waitcnt vmcnt(4)
    buffer_load_dwordx4 v88, s[8:11], s96 offen nt lds
    s_waitcnt lgkmcnt(0)
    v_mfma_f32_16x16x32_bf16 v[48:51], v[32:35], a[236:239], 0
    v_mfma_f32_16x16x32_bf16 v[52:55], v[32:35], v[32:35], 0
    v_mfma_f32_16x16x32_bf16 v[48:51], v[36:39], a[240:243], v[48:51]
    v_mfma_f32_16x16x32_bf16 v[52:55], v[36:39], v[36:39], v[52:55]
    v_mfma_f32_16x16x32_bf16 v[48:51], v[40:43], a[244:247], v[48:51]
    v_mfma_f32_16x16x32_bf16 v[52:55], v[40:43], v[40:43], v[52:55]
    v_mfma_f32_16x16x32_bf16 v[48:51], v[44:47], a[248:251], v[48:51]
    v_mfma_f32_16x16x32_bf16 v[52:55], v[44:47], v[44:47], v[52:55]
    s_mov_b64 exec, s[62:63]
    s_nop 5
    ds_write_b32 v13, v48
    s_mov_b64 exec, s[54:55]
    ds_write_b32 v13, v49 offset:272
    ds_write_b32 v13, v50 offset:544
    ds_write_b32 v13, v51 offset:816
    s_mov_b64 exec, -1
    v_cndmask_b32 v28, v52, v53, s[42:43]
    v_cndmask_b32 v28, v28, v54, s[44:45]
    v_cndmask_b32 v28, v28, v55, s[46:47]
    s_mov_b64 exec, s[48:49]
    ds_write_b32 v15, v28 offset:10240
    s_mov_b64 exec, -1
    s_waitcnt lgkmcnt(0)
    s_barrier
    s_add_u32 m0, s101, 1024
    s_xor_b32 s96, s98, 26624
    s_waitcnt vmcnt(4)
    buffer_load_dwordx4 v89, s[8:11], s96 offen nt lds
    s_add_u32 m0, s101, 2048
    s_xor_b32 s96, s98, 28672
    s_waitcnt vmcnt(4)
    buffer_load_dwordx4 v90, s[8:11], s96 offen nt lds
    s_cmp_lg_u32 s24, 0
    s_cbranch_scc1 L_w0skip_26
    s_mov_b64 exec, s[54:55]
    ds_read_b128 v[68:71], v95 offset:10240
    ds_read_b128 v[72:75], v95 offset:10256
    ds_read_b128 v[32:35], v94 offset:0
    ds_read_b128 v[36:39], v94 offset:2560
    ds_read_b128 v[40:43], v94 offset:5120
    ds_read_b128 v[44:47], v94 offset:7680
    v_lshrrev_b32 v28, 4, v1
    v_lshlrev_b32 v28, 5, v28
    v_and_b32 v29, 1, v1
    v_lshl_add_u32 v28, v29, 4, v28
    ds_read_b128 v[48:51], v28 offset:2176
    ds_read_b128 v[52:55], v28 offset:4736
    ds_read_b128 v[56:59], v28 offset:7296
    ds_read_b128 v[60:63], v28 offset:9856
    s_waitcnt lgkmcnt(0)
    v_pk_add_f32 v[48:49], v[48:49], v[52:53]
    v_pk_add_f32 v[50:51], v[50:51], v[54:55]
    v_pk_add_f32 v[56:57], v[56:57], v[60:61]
    v_pk_add_f32 v[58:59], v[58:59], v[62:63]
    v_pk_add_f32 v[48:49], v[48:49], v[56:57]
    v_pk_add_f32 v[50:51], v[50:51], v[58:59]
    v_accvgpr_write_b32 a232, v48
    v_accvgpr_write_b32 a233, v49
    v_accvgpr_write_b32 a234, v50
    v_accvgpr_write_b32 a235, v51
    v_add_f32 v68, v68, v69
    v_add_f32 v72, v72, v73
    v_add_f32 v70, v70, v71
    v_add_f32 v74, v74, v75
    v_add_f32 v68, v68, v70
    v_add_f32 v72, v72, v74
    v_mul_f32 v76, 0x3b000000, v68
    v_mul_f32 v77, 0x3b000000, v72
    v_fma_f32 v77, -v76, v76, v77
    v_max_f32 v77, 0, v77
    v_add_f32 v77, 0x3727c5ac, v77
    v_rsq_f32 v77, v77
    v_pk_add_f32 v[32:33], v[32:33], v[36:37]
    v_pk_add_f32 v[34:35], v[34:35], v[38:39]
    v_pk_add_f32 v[40:41], v[40:41], v[44:45]
    v_pk_add_f32 v[42:43], v[42:43], v[46:47]
    v_pk_add_f32 v[32:33], v[32:33], v[40:41]
    v_pk_add_f32 v[34:35], v[34:35], v[42:43]
    v_fma_f32 v32, -v76, v48, v32
    v_fma_f32 v33, -v76, v49, v33
    v_fma_f32 v34, -v76, v50, v34
    v_fma_f32 v35, -v76, v51, v35
    v_mul_f32 v32, v77, v32
    v_mul_f32 v33, v77, v33
    v_mul_f32 v34, v77, v34
    v_mul_f32 v35, v77, v35
    v_cvt_pk_bf16_f32 v28, v32, v33
    v_cvt_pk_bf16_f32 v29, v34, v35
    buffer_store_dwordx2 v[28:29], v93, s[4:7], s32 offen sc1
    s_mov_b64 exec, -1
L_w0skip_26:
    s_add_u32 m0, s101, 3072
    s_xor_b32 s96, s98, 30720
    s_waitcnt vmcnt(4)
    buffer_load_dwordx4 v91, s[8:11], s96 offen nt lds
    s_waitcnt vmcnt(4)
    ds_read_b128 a[32:35], v64 offset:8192
    ds_read_b128 a[36:39], v65 offset:8192
    ds_read_b128 a[40:43], v66 offset:8192
    ds_read_b128 a[44:47], v67 offset:8192
    s_waitcnt lgkmcnt(0)
    s_add_u32 m0, s101, 4096
    s_xor_b32 s96, s98, 1024
    s_waitcnt vmcnt(4)
    buffer_load_dwordx4 v88, s[8:11], s96 offen nt lds
    s_add_u32 m0, s101, 5120
    s_xor_b32 s96, s98, 3072
    s_waitcnt vmcnt(4)
    buffer_load_dwordx4 v89, s[8:11], s96 offen nt lds
    s_add_u32 m0, s101, 6144
    s_xor_b32 s96, s98, 5120
    s_waitcnt vmcnt(4)
    buffer_load_dwordx4 v90, s[8:11], s96 offen nt lds
    s_add_u32 m0, s101, 7168
    s_xor_b32 s96, s98, 7168
    s_waitcnt vmcnt(4)
    buffer_load_dwordx4 v91, s[8:11], s96 offen nt lds
    s_waitcnt vmcnt(4)
    ds_read_b128 a[48:51], v64 offset:0
    ds_read_b128 a[52:55], v65 offset:0
    ds_read_b128 a[56:59], v66 offset:0
    ds_read_b128 a[60:63], v67 offset:0
    s_waitcnt lgkmcnt(0)
    s_add_u32 m0, s101, 8192
    s_xor_b32 s96, s98, 9216
    s_waitcnt vmcnt(4)
    buffer_load_dwordx4 v88, s[8:11], s96 offen nt lds
    s_add_u32 m0, s101, 9216
    s_xor_b32 s96, s98, 11264
    s_waitcnt vmcnt(4)
    buffer_load_dwordx4 v89, s[8:11], s96 offen nt lds
    s_add_u32 m0, s101, 10240
    s_xor_b32 s96, s98, 13312
    s_waitcnt vmcnt(4)
    buffer_load_dwordx4 v90, s[8:11], s96 offen nt lds
    s_add_u32 m0, s101, 11264
    s_xor_b32 s96, s98, 15360
    s_waitcnt vmcnt(4)
    buffer_load_dwordx4 v91, s[8:11], s96 offen nt lds
    s_waitcnt vmcnt(4)
    ds_read_b128 a[64:67], v64 offset:4096
    ds_read_b128 a[68:71], v65 offset:4096
    ds_read_b128 a[72:75], v66 offset:4096
    ds_read_b128 a[76:79], v67 offset:4096
    s_waitcnt lgkmcnt(0)
    s_add_u32 m0, s101, 0
    s_xor_b32 s96, s98, 17408
    s_waitcnt vmcnt(4)
    buffer_load_dwordx4 v88, s[8:11], s96 offen nt lds
    s_add_u32 m0, s101, 1024
    s_xor_b32 s96, s98, 19456
    s_waitcnt vmcnt(4)
    buffer_load_dwordx4 v89, s[8:11], s96 offen nt lds
    s_add_u32 m0, s101, 2048
    s_xor_b32 s96, s98, 21504
    s_waitcnt vmcnt(4)
    buffer_load_dwordx4 v90, s[8:11], s96 offen nt lds
    s_add_u32 m0, s101, 3072
    s_xor_b32 s96, s98, 23552
    s_waitcnt vmcnt(4)
    buffer_load_dwordx4 v91, s[8:11], s96 offen nt lds
    s_waitcnt vmcnt(4)
    ds_read_b128 a[80:83], v64 offset:8192
    ds_read_b128 a[84:87], v65 offset:8192
    ds_read_b128 a[88:91], v66 offset:8192
    ds_read_b128 a[92:95], v67 offset:8192
    s_waitcnt lgkmcnt(0)
    s_add_u32 m0, s101, 4096
    s_xor_b32 s96, s98, 25600
    s_waitcnt vmcnt(4)
    buffer_load_dwordx4 v88, s[8:11], s96 offen nt lds
    s_add_u32 m0, s101, 5120
    s_xor_b32 s96, s98, 27648
    s_waitcnt vmcnt(4)
    buffer_load_dwordx4 v89, s[8:11], s96 offen nt lds
    s_add_u32 m0, s101, 6144
    s_xor_b32 s96, s98, 29696
    s_waitcnt vmcnt(4)
    buffer_load_dwordx4 v90, s[8:11], s96 offen nt lds
    s_add_u32 m0, s101, 7168
    s_xor_b32 s96, s98, 31744
    s_waitcnt vmcnt(4)
    buffer_load_dwordx4 v91, s[8:11], s96 offen nt lds
    s_waitcnt vmcnt(4)
    ds_read_b128 a[96:99], v64 offset:0
    ds_read_b128 a[100:103], v65 offset:0
    ds_read_b128 a[104:107], v66 offset:0
    ds_read_b128 a[108:111], v67 offset:0
    s_cmp_lg_u32 s24, 0
    s_cbranch_scc1 L_w0skip_27
    v_and_b32 v84, 3, v1
    v_lshlrev_b32 v84, 6, v84
    v_bfe_u32 v85, v1, 2, 1
    v_lshl_add_u32 v84, v85, 2, v84
    s_mov_b64 exec, 0xff
    global_load_dword v85, v84, s[84:85] sc1
    s_mov_b64 exec, -1
L_w0skip_27:
    s_xor_b32 s96, s99, 0
    s_waitcnt vmcnt(4)
    buffer_load_dwordx4 v[128:131], v0, s[12:15], s96 offen nt
    s_xor_b32 s96, s99, 256
    s_waitcnt vmcnt(4)
    buffer_load_dwordx4 v[132:135], v0, s[12:15], s96 offen nt
    s_xor_b32 s96, s99, 512
    s_waitcnt vmcnt(4)
    buffer_load_dwordx4 v[136:139], v0, s[12:15], s96 offen nt
    s_xor_b32 s96, s99, 768
    s_waitcnt vmcnt(4)
    buffer_load_dwordx4 v[140:143], v0, s[12:15], s96 offen nt
    s_waitcnt vmcnt(4)
    ds_read_b128 a[112:115], v64 offset:4096
    ds_read_b128 a[116:119], v65 offset:4096
    ds_read_b128 a[120:123], v66 offset:4096
    ds_read_b128 a[124:127], v67 offset:4096
    s_xor_b32 s96, s99, 1024
    s_waitcnt vmcnt(4)
    buffer_load_dwordx4 v[144:147], v0, s[12:15], s96 offen nt
    s_cmp_lg_u32 s24, 0
    s_cbranch_scc1 L_w0skip_28
    s_waitcnt vmcnt(5)
    s_mov_b64 exec, 0xff
    v_cmp_gt_u32 vcc, 32, v85
    s_cbranch_vccz L_cntd_30
    s_mov_b32 s28, s27
L_cnt_29:
    s_sleep 8
    global_load_dword v85, v84, s[84:85] sc1
    s_waitcnt vmcnt(0)
    v_cmp_gt_u32 vcc, 32, v85
    s_cbranch_vccz L_cntd_30
    s_sub_u32 s28, s28, 1
    s_cbranch_scc0 L_cnt_29
    s_mov_b32 s27, 0
L_cntd_30:
    s_mov_b64 exec, -1
    v_lshlrev_b32 v28, 5, v1
    s_lshl_b32 s29, s20, 2
    v_add_u32 v28, s29, v28
    s_mov_b64 exec, s[54:55]
    s_mov_b32 s30, 1507328
    buffer_load_dword v40, v28, s[4:7], s30 offen sc1
    s_mov_b64 exec, -1
    s_lshl_b32 s29, s22, 5
    v_lshlrev_b32 v86, 4, v1
    v_lshrrev_b32 v87, 1, v1
    v_lshlrev_b32 v87, 8, v87
    v_and_b32 v29, 1, v1
    v_lshl_add_u32 v87, v29, 4, v87
    v_add_u32 v87, s29, v87
    buffer_load_dwordx4 v[32:35], v87, s[4:7], s32 offen sc1
L_w0skip_28:
    s_xor_b32 s96, s99, 1280
    s_waitcnt vmcnt(4)
    buffer_load_dwordx4 v[148:151], v0, s[12:15], s96 offen nt
    s_xor_b32 s96, s99, 1536
    s_waitcnt vmcnt(4)
    buffer_load_dwordx4 v[152:155], v0, s[12:15], s96 offen nt
    s_xor_b32 s96, s99, 1792
    s_waitcnt vmcnt(4)
    buffer_load_dwordx4 v[156:159], v0, s[12:15], s96 offen nt
    s_xor_b32 s96, s99, 8192
    s_waitcnt vmcnt(4)
    buffer_load_dwordx4 v[160:163], v0, s[12:15], s96 offen nt
    s_xor_b32 s96, s99, 8448
    s_waitcnt vmcnt(4)
    buffer_load_dwordx4 v[164:167], v0, s[12:15], s96 offen nt
    s_cmp_lg_u32 s24, 0
    s_cbranch_scc1 L_w0skip_31
    s_waitcnt vmcnt(5)
    v_max3_u32 v28, v32, v33, v34
    v_max_u32 v28, v28, v35
    v_cmp_eq_u32 vcc, -1, v28
    s_cbranch_vccz L_qok_32
    s_lshl_b32 s29, s22, 5
    v_lshlrev_b32 v86, 4, v1
    v_lshrrev_b32 v87, 1, v1
    v_lshlrev_b32 v87, 8, v87
    v_and_b32 v29, 1, v1
    v_lshl_add_u32 v87, v29, 4, v87
    v_add_u32 v87, s29, v87
    s_mov_b32 s28, s27
L_pq0_33:
    buffer_load_dwordx4 v[32:35], v87, s[4:7], s32 offen sc1
    s_waitcnt vmcnt(0)
    v_max3_u32 v28, v32, v33, v34
    v_max_u32 v28, v28, v35
    v_cmp_eq_u32 vcc, -1, v28
    s_cbranch_vccz L_pq0d_34
    s_sub_u32 s28, s28, 1
    s_cbranch_scc0 L_pq0_33
    s_mov_b32 s27, 0
L_pq0d_34:
L_qok_32:
    ds_write_b128 v86, v[32:35] offset:21248
    s_getreg_b32 s29, hwreg(HW_REG_XCC_ID, 0, 4)
    s_mov_b64 exec, s[54:55]
    v_cmp_ne_u32 vcc, s29, v40
    s_mov_b64 exec, -1
    s_cmp_eq_u64 vcc, 0
    s_cselect_b32 s26, 1, 0
    v_mov_b32 v28, s26
    v_mov_b32 v29, 0
    ds_write_b32 v29, v28 offset:22272
L_w0skip_31:
    s_xor_b32 s96, s99, 8704
    s_waitcnt vmcnt(4)
    buffer_load_dwordx4 v[168:171], v0, s[12:15], s96 offen nt
    s_xor_b32 s96, s99, 8960
    s_waitcnt vmcnt(4)
    buffer_load_dwordx4 v[172:175], v0, s[12:15], s96 offen nt
    s_xor_b32 s96, s99, 9216
    s_waitcnt vmcnt(4)
    buffer_load_dwordx4 v[176:179], v0, s[12:15], s96 offen nt
    s_xor_b32 s96, s99, 9472
    s_waitcnt vmcnt(4)
    buffer_load_dwordx4 v[180:183], v0, s[12:15], s96 offen nt
    s_xor_b32 s96, s99, 9728
    s_waitcnt vmcnt(4)
    buffer_load_dwordx4 v[184:187], v0, s[12:15], s96 offen nt
    s_xor_b32 s96, s99, 9984
    s_waitcnt vmcnt(4)
    buffer_load_dwordx4 v[188:191], v0, s[12:15], s96 offen nt
    s_xor_b32 s96, s99, 16384
    s_waitcnt vmcnt(4)
    buffer_load_dwordx4 v[192:195], v0, s[12:15], s96 offen nt
    s_xor_b32 s96, s99, 16640
    s_waitcnt vmcnt(4)
    buffer_load_dwordx4 v[196:199], v0, s[12:15], s96 offen nt
    s_xor_b32 s96, s99, 16896
    s_waitcnt vmcnt(4)
    buffer_load_dwordx4 v[200:203], v0, s[12:15], s96 offen nt
    s_xor_b32 s96, s99, 17152
    s_waitcnt vmcnt(4)
    buffer_load_dwordx4 v[204:207], v0, s[12:15], s96 offen nt
    s_waitcnt lgkmcnt(0)
    s_barrier
    v_and_b32 v28, 3, v2
    v_lshlrev_b32 v28, 8, v28
    v_lshl_add_u32 v28, v3, 4, v28
    ds_read_b128 v[64:67], v28 offset:21248
    ds_read_b128 v[68:71], v28 offset:21312
    ds_read_b128 v[72:75], v28 offset:21376
    ds_read_b128 v[76:79], v28 offset:21440
    v_mov_b32 v29, 0
    ds_read_b32 v30, v29 offset:22272
    s_xor_b32 s96, s99, 17408
    s_waitcnt vmcnt(9)
    buffer_load_dwordx4 v[208:211], v0, s[12:15], s96 offen nt
    s_xor_b32 s96, s99, 17664
    s_waitcnt vmcnt(9)
    buffer_load_dwordx4 v[212:215], v0, s[12:15], s96 offen nt
    s_xor_b32 s96, s99, 17920
    s_waitcnt vmcnt(9)
    buffer_load_dwordx4 v[216:219], v0, s[12:15], s96 offen nt
    s_xor_b32 s96, s99, 18176
    s_waitcnt vmcnt(9)
    buffer_load_dwordx4 v[220:223], v0, s[12:15], s96 offen nt
    s_xor_b32 s96, s99, 24576
    s_waitcnt vmcnt(9)
    buffer_load_dwordx4 v[224:227], v0, s[12:15], s96 offen nt
    s_xor_b32 s96, s99, 24832
    s_waitcnt vmcnt(9)
    buffer_load_dwordx4 v[228:231], v0, s[12:15], s96 offen nt
    s_waitcnt lgkmcnt(0)
    v_readfirstlane_b32 s26, v30
    v_mfma_f32_16x16x32_bf16 v[32:35], a[0:3], v[64:67], 0
    v_mfma_f32_16x16x32_bf16 v[32:35], a[4:7], v[68:71], v[32:35]
    v_mfma_f32_16x16x32_bf16 v[32:35], a[8:11], v[72:75], v[32:35]
    v_mfma_f32_16x16x32_bf16 v[32:35], a[12:15], v[76:79], v[32:35]
    v_mfma_f32_16x16x32_bf16 v[36:39], a[16:19], v[64:67], 0
    v_mfma_f32_16x16x32_bf16 v[36:39], a[20:23], v[68:71], v[36:39]
    v_mfma_f32_16x16x32_bf16 v[36:39], a[24:27], v[72:75], v[36:39]
    v_mfma_f32_16x16x32_bf16 v[36:39], a[28:31], v[76:79], v[36:39]
    s_xor_b32 s96, s99, 25088
    s_waitcnt vmcnt(9)
    buffer_load_dwordx4 v[232:235], v0, s[12:15], s96 offen nt
    v_mfma_f32_16x16x32_bf16 v[40:43], a[32:35], v[64:67], 0
    v_mfma_f32_16x16x32_bf16 v[40:43], a[36:39], v[68:71], v[40:43]
    v_mfma_f32_16x16x32_bf16 v[40:43], a[40:43], v[72:75], v[40:43]
    v_mfma_f32_16x16x32_bf16 v[40:43], a[44:47], v[76:79], v[40:43]
    v_mfma_f32_16x16x32_bf16 v[44:47], a[48:51], v[64:67], 0
    v_mul_f32_dpp v80, v32, v17 quad_perm:[0,1,2,3] row_mask:0xf bank_mask:0x1
    v_mfma_f32_16x16x32_bf16 v[44:47], a[52:55], v[68:71], v[44:47]
    v_mul_f32_dpp v81, v33, v17 quad_perm:[0,1,2,3] row_mask:0xf bank_mask:0x1
    v_mfma_f32_16x16x32_bf16 v[44:47], a[56:59], v[72:75], v[44:47]
    v_mul_f32_dpp v82, v34, v17 quad_perm:[0,1,2,3] row_mask:0xf bank_mask:0x1
    v_mfma_f32_16x16x32_bf16 v[44:47], a[60:63], v[76:79], v[44:47]
    v_mul_f32_dpp v83, v35, v17 quad_perm:[0,1,2,3] row_mask:0xf bank_mask:0x1
    s_xor_b32 s96, s99, 25344
    s_waitcnt vmcnt(9)
    buffer_load_dwordx4 v[236:239], v0, s[12:15], s96 offen nt
    v_mfma_f32_16x16x32_bf16 v[48:51], a[64:67], v[64:67], 0
    v_mul_f32_dpp v80, v36, v17 quad_perm:[0,1,2,3] row_mask:0xf bank_mask:0x2
    v_mfma_f32_16x16x32_bf16 v[48:51], a[68:71], v[68:71], v[48:51]
    v_mul_f32_dpp v81, v37, v17 quad_perm:[0,1,2,3] row_mask:0xf bank_mask:0x2
    v_mfma_f32_16x16x32_bf16 v[48:51], a[72:75], v[72:75], v[48:51]
    v_mul_f32_dpp v82, v38, v17 quad_perm:[0,1,2,3] row_mask:0xf bank_mask:0x2
    v_mfma_f32_16x16x32_bf16 v[48:51], a[76:79], v[76:79], v[48:51]
    v_mul_f32_dpp v83, v39, v17 quad_perm:[0,1,2,3] row_mask:0xf bank_mask:0x2
    v_mfma_f32_16x16x32_bf16 v[52:55], a[80:83], v[64:67], 0
    v_mul_f32_dpp v80, v40, v17 quad_perm:[0,1,2,3] row_mask:0xf bank_mask:0x4
    v_mfma_f32_16x16x32_bf16 v[52:55], a[84:87], v[68:71], v[52:55]
    v_mul_f32_dpp v81, v41, v17 quad_perm:[0,1,2,3] row_mask:0xf bank_mask:0x4
    v_mfma_f32_16x16x32_bf16 v[52:55], a[88:91], v[72:75], v[52:55]
    v_mul_f32_dpp v82, v42, v17 quad_perm:[0,1,2,3] row_mask:0xf bank_mask:0x4
    v_mfma_f32_16x16x32_bf16 v[52:55], a[92:95], v[76:79], v[52:55]
    v_mul_f32_dpp v83, v43, v17 quad_perm:[0,1,2,3] row_mask:0xf bank_mask:0x4
    s_xor_b32 s96, s99, 25600
    s_waitcnt vmcnt(9)
    buffer_load_dwordx4 v[240:243], v0, s[12:15], s96 offen nt
    v_mfma_f32_16x16x32_bf16 v[56:59], a[96:99], v[64:67], 0
    v_mul_f32_dpp v80, v44, v17 quad_perm:[0,1,2,3] row_mask:0xf bank_mask:0x8
    v_mfma_f32_16x16x32_bf16 v[56:59], a[100:103], v[68:71], v[56:59]
    v_mul_f32_dpp v81, v45, v17 quad_perm:[0,1,2,3] row_mask:0xf bank_mask:0x8
    v_mfma_f32_16x16x32_bf16 v[56:59], a[104:107], v[72:75], v[56:59]
    v_mul_f32_dpp v82, v46, v17 quad_perm:[0,1,2,3] row_mask:0xf bank_mask:0x8
    v_mfma_f32_16x16x32_bf16 v[56:59], a[108:111], v[76:79], v[56:59]
    v_mul_f32_dpp v83, v47, v17 quad_perm:[0,1,2,3] row_mask:0xf bank_mask:0x8
    v_mfma_f32_16x16x32_bf16 v[60:63], a[112:115], v[64:67], 0
    v_mul_f32_dpp v84, v48, v17 quad_perm:[0,1,2,3] row_mask:0xf bank_mask:0x1
    v_mfma_f32_16x16x32_bf16 v[60:63], a[116:119], v[68:71], v[60:63]
    v_mul_f32_dpp v85, v49, v17 quad_perm:[0,1,2,3] row_mask:0xf bank_mask:0x1
    v_mfma_f32_16x16x32_bf16 v[60:63], a[120:123], v[72:75], v[60:63]
    v_mul_f32_dpp v86, v50, v17 quad_perm:[0,1,2,3] row_mask:0xf bank_mask:0x1
    v_mfma_f32_16x16x32_bf16 v[60:63], a[124:127], v[76:79], v[60:63]
    v_mul_f32_dpp v87, v51, v17 quad_perm:[0,1,2,3] row_mask:0xf bank_mask:0x1
    v_mul_f32_dpp v84, v52, v17 quad_perm:[0,1,2,3] row_mask:0xf bank_mask:0x2
    v_mul_f32_dpp v85, v53, v17 quad_perm:[0,1,2,3] row_mask:0xf bank_mask:0x2
    v_mul_f32_dpp v86, v54, v17 quad_perm:[0,1,2,3] row_mask:0xf bank_mask:0x2
    v_mul_f32_dpp v87, v55, v17 quad_perm:[0,1,2,3] row_mask:0xf bank_mask:0x2
    v_mul_f32_dpp v84, v56, v17 quad_perm:[0,1,2,3] row_mask:0xf bank_mask:0x4
    v_mul_f32_dpp v85, v57, v17 quad_perm:[0,1,2,3] row_mask:0xf bank_mask:0x4
    v_mul_f32_dpp v86, v58, v17 quad_perm:[0,1,2,3] row_mask:0xf bank_mask:0x4
    v_mul_f32_dpp v87, v59, v17 quad_perm:[0,1,2,3] row_mask:0xf bank_mask:0x4
    v_mul_f32_dpp v84, v60, v17 quad_perm:[0,1,2,3] row_mask:0xf bank_mask:0x8
    v_mul_f32_dpp v85, v61, v17 quad_perm:[0,1,2,3] row_mask:0xf bank_mask:0x8
    v_mul_f32_dpp v86, v62, v17 quad_perm:[0,1,2,3] row_mask:0xf bank_mask:0x8
    v_mul_f32_dpp v87, v63, v17 quad_perm:[0,1,2,3] row_mask:0xf bank_mask:0x8
    s_xor_b32 s96, s99, 25856
    s_waitcnt vmcnt(9)
    buffer_load_dwordx4 v[244:247], v0, s[12:15], s96 offen nt
    v_max3_f32 v28, v80, v81, v82
    v_max3_f32 v29, v83, v84, v85
    v_max3_f32 v28, v28, v86, v87
    v_max_f32 v28, v28, v29
    s_nop 1
    v_max_f32_dpp v28, v28, v28 row_ror:4 row_mask:0xf bank_mask:0xf
    s_nop 1
    v_max_f32_dpp v28, v28, v28 row_ror:8 row_mask:0xf bank_mask:0xf
    v_mov_b32 v29, v28
    s_nop 1
    v_permlane16_swap_b32 v28, v29
    v_max_f32 v28, v28, v29
    v_mov_b32 v29, v28
    s_nop 1
    v_permlane32_swap_b32 v28, v29
    v_max_f32 v28, v28, v29
    s_xor_b32 s96, s99, 26112
    s_waitcnt vmcnt(9)
    buffer_load_dwordx4 v[248:251], v0, s[12:15], s96 offen nt
    v_pk_add_f32 v[80:81], v[80:81], v[28:29] op_sel_hi:[1,0] neg_lo:[0,1] neg_hi:[0,1]
    v_pk_add_f32 v[82:83], v[82:83], v[28:29] op_sel_hi:[1,0] neg_lo:[0,1] neg_hi:[0,1]
    v_pk_add_f32 v[84:85], v[84:85], v[28:29] op_sel_hi:[1,0] neg_lo:[0,1] neg_hi:[0,1]
    v_pk_add_f32 v[86:87], v[86:87], v[28:29] op_sel_hi:[1,0] neg_lo:[0,1] neg_hi:[0,1]
    v_exp_f32 v80, v80
    v_exp_f32 v81, v81
    v_exp_f32 v82, v82
    v_exp_f32 v83, v83
    v_exp_f32 v84, v84
    v_exp_f32 v85, v85
    v_exp_f32 v86, v86
    v_exp_f32 v87, v87
    s_xor_b32 s96, s99, 26368
    s_waitcnt vmcnt(9)
    buffer_load_dwordx4 v[252:255], v0, s[12:15], s96 offen nt
    v_cvt_pk_bf16_f32 v88, v80, v81
    v_cvt_pk_bf16_f32 v89, v82, v83
    v_cvt_pk_bf16_f32 v90, v84, v85
    v_cvt_pk_bf16_f32 v91, v86, v87
    s_mov_b32 s30, 0x05040100
    s_mov_b32 s90, 0x07060302
    s_waitcnt vmcnt(24)
    v_perm_b32 v96, v132, v128, s30
    v_perm_b32 v97, v140, v136, s30
    v_perm_b32 v98, v148, v144, s30
    v_perm_b32 v99, v156, v152, s30
    v_perm_b32 v100, v132, v128, s90
    v_perm_b32 v101, v140, v136, s90
    v_perm_b32 v102, v148, v144, s90
    v_perm_b32 v103, v156, v152, s90
    v_mfma_f32_16x16x32_bf16 v[32:35], v[96:99], v[88:91], 0
    v_perm_b32 v104, v133, v129, s30
    v_perm_b32 v105, v141, v137, s30
    v_perm_b32 v106, v149, v145, s30
    v_perm_b32 v107, v157, v153, s30
    v_mov_b32_dpp v68, v88 row_shl:4 row_mask:0xf bank_mask:0xf
    v_mov_b32_dpp v69, v89 row_shl:4 row_mask:0xf bank_mask:0xf
    v_mfma_f32_16x16x32_bf16 v[36:39], v[100:103], v[88:91], 0
    v_perm_b32 v108, v133, v129, s90
    v_perm_b32 v109, v141, v137, s90
    v_perm_b32 v110, v149, v145, s90
    v_perm_b32 v111, v157, v153, s90
    v_mov_b32_dpp v70, v90 row_shl:4 row_mask:0xf bank_mask:0xf
    v_mov_b32_dpp v71, v91 row_shl:4 row_mask:0xf bank_mask:0xf
    v_mfma_f32_16x16x32_bf16 v[40:43], v[104:107], v[88:91], 0
    v_perm_b32 v112, v134, v130, s30
    v_perm_b32 v113, v142, v138, s30
    v_perm_b32 v114, v150, v146, s30
    v_perm_b32 v115, v158, v154, s30
    v_mov_b32_dpp v72, v88 row_shl:8 row_mask:0xf bank_mask:0xf
    v_mov_b32_dpp v73, v89 row_shl:8 row_mask:0xf bank_mask:0xf
    v_mfma_f32_16x16x32_bf16 v[44:47], v[108:111], v[88:91], 0
    v_perm_b32 v116, v134, v130, s90
    v_perm_b32 v117, v142, v138, s90
    v_perm_b32 v118, v150, v146, s90
    v_perm_b32 v119, v158, v154, s90
    v_mov_b32_dpp v74, v90 row_shl:8 row_mask:0xf bank_mask:0xf
    v_mov_b32_dpp v75, v91 row_shl:8 row_mask:0xf bank_mask:0xf
    v_mfma_f32_16x16x32_bf16 v[48:51], v[112:115], v[88:91], 0
    v_perm_b32 v120, v135, v131, s30
    v_perm_b32 v121, v143, v139, s30
    v_perm_b32 v122, v151, v147, s30
    v_perm_b32 v123, v159, v155, s30
    v_mov_b32_dpp v76, v88 row_shl:12 row_mask:0xf bank_mask:0xf
    v_mfma_f32_16x16x32_bf16 v[52:55], v[116:119], v[88:91], 0
    v_perm_b32 v124, v135, v131, s90
    v_perm_b32 v125, v143, v139, s90
    v_perm_b32 v126, v151, v147, s90
    v_perm_b32 v127, v159, v155, s90
    v_mov_b32_dpp v77, v89 row_shl:12 row_mask:0xf bank_mask:0xf
    v_mfma_f32_16x16x32_bf16 v[56:59], v[120:123], v[88:91], 0
    v_mov_b32_dpp v78, v90 row_shl:12 row_mask:0xf bank_mask:0xf
    v_mfma_f32_16x16x32_bf16 v[60:63], v[124:127], v[88:91], 0
    v_mov_b32_dpp v79, v91 row_shl:12 row_mask:0xf bank_mask:0xf
    s_waitcnt vmcnt(16)
    v_perm_b32 v128, v164, v160, s30
    v_perm_b32 v129, v172, v168, s30
    v_perm_b32 v130, v180, v176, s30
    v_perm_b32 v131, v188, v184, s30
    v_perm_b32 v132, v164, v160, s90
    v_perm_b32 v133, v172, v168, s90
    v_perm_b32 v134, v180, v176, s90
    v_perm_b32 v135, v188, v184, s90
    v_mfma_f32_16x16x32_bf16 v[32:35], v[128:131], v[68:71], v[32:35]
    v_perm_b32 v136, v165, v161, s30
    v_perm_b32 v137, v173, v169, s30
    v_perm_b32 v138, v181, v177, s30
    v_perm_b32 v139, v189, v185, s30
    v_add_f32 v30, v80, v81
    v_mfma_f32_16x16x32_bf16 v[36:39], v[132:135], v[68:71], v[36:39]
    v_perm_b32 v140, v165, v161, s90
    v_perm_b32 v141, v173, v169, s90
    v_perm_b32 v142, v181, v177, s90
    v_perm_b32 v143, v189, v185, s90
    v_add_f32 v29, v82, v83
    v_mfma_f32_16x16x32_bf16 v[40:43], v[136:139], v[68:71], v[40:43]
    v_perm_b32 v144, v166, v162, s30
    v_perm_b32 v145, v174, v170, s30
    v_perm_b32 v146, v182, v178, s30
    v_perm_b32 v147, v190, v186, s30
    v_add_f32 v30, v30, v84
    v_mfma_f32_16x16x32_bf16 v[44:47], v[140:143], v[68:71], v[44:47]
    v_perm_b32 v148, v166, v162, s90
    v_perm_b32 v149, v174, v170, s90
    v_perm_b32 v150, v182, v178, s90
    v_perm_b32 v151, v190, v186, s90
    v_add_f32 v29, v29, v85
    v_mfma_f32_16x16x32_bf16 v[48:51], v[144:147], v[68:71], v[48:51]
    v_perm_b32 v152, v167, v163, s30
    v_perm_b32 v153, v175, v171, s30
    v_perm_b32 v154, v183, v179, s30
    v_perm_b32 v155, v191, v187, s30
    v_add_f32 v30, v30, v86
    v_mfma_f32_16x16x32_bf16 v[52:55], v[148:151], v[68:71], v[52:55]
    v_perm_b32 v156, v167, v163, s90
    v_perm_b32 v157, v175, v171, s90
    v_perm_b32 v158, v183, v179, s90
    v_perm_b32 v159, v191, v187, s90
    v_add_f32 v29, v29, v87
    v_mfma_f32_16x16x32_bf16 v[56:59], v[152:155], v[68:71], v[56:59]
    v_add_f32 v30, v30, v29
    v_mfma_f32_16x16x32_bf16 v[60:63], v[156:159], v[68:71], v[60:63]
    s_nop 0
    v_add_f32_dpp v30, v30, v30 row_ror:4 row_mask:0xf bank_mask:0xf
    s_waitcnt vmcnt(8)
    v_perm_b32 v160, v196, v192, s30
    v_perm_b32 v161, v204, v200, s30
    v_perm_b32 v162, v212, v208, s30
    v_perm_b32 v163, v220, v216, s30
    v_perm_b32 v164, v196, v192, s90
    v_perm_b32 v165, v204, v200, s90
    v_perm_b32 v166, v212, v208, s90
    v_perm_b32 v167, v220, v216, s90
    v_mfma_f32_16x16x32_bf16 v[32:35], v[160:163], v[72:75], v[32:35]
    v_perm_b32 v168, v197, v193, s30
    v_perm_b32 v169, v205, v201, s30
    v_perm_b32 v170, v213, v209, s30
    v_perm_b32 v171, v221, v217, s30
    v_add_f32_dpp v30, v30, v30 row_ror:8 row_mask:0xf bank_mask:0xf
    v_mfma_f32_16x16x32_bf16 v[36:39], v[164:167], v[72:75], v[36:39]
    v_perm_b32 v172, v197, v193, s90
    v_perm_b32 v173, v205, v201, s90
    v_perm_b32 v174, v213, v209, s90
    v_perm_b32 v175, v221, v217, s90
    v_mov_b32 v29, v30
    v_mfma_f32_16x16x32_bf16 v[40:43], v[168:171], v[72:75], v[40:43]
    v_perm_b32 v176, v198, v194, s30
    v_perm_b32 v177, v206, v202, s30
    v_perm_b32 v178, v214, v210, s30
    v_perm_b32 v179, v222, v218, s30
    v_permlane16_swap_b32 v30, v29
    v_mfma_f32_16x16x32_bf16 v[44:47], v[172:175], v[72:75], v[44:47]
    v_perm_b32 v180, v198, v194, s90
    v_perm_b32 v181, v206, v202, s90
    v_perm_b32 v182, v214, v210, s90
    v_perm_b32 v183, v222, v218, s90
    v_add_f32 v30, v30, v29
    v_mfma_f32_16x16x32_bf16 v[48:51], v[176:179], v[72:75], v[48:51]
    v_perm_b32 v184, v199, v195, s30
    v_perm_b32 v185, v207, v203, s30
    v_perm_b32 v186, v215, v211, s30
    v_perm_b32 v187, v223, v219, s30
    v_mov_b32 v29, v30
    v_mfma_f32_16x16x32_bf16 v[52:55], v[180:183], v[72:75], v[52:55]
    v_perm_b32 v188, v199, v195, s90
    v_perm_b32 v189, v207, v203, s90
    v_perm_b32 v190, v215, v211, s90
    v_perm_b32 v191, v223, v219, s90
    v_permlane32_swap_b32 v30, v29
    v_mfma_f32_16x16x32_bf16 v[56:59], v[184:187], v[72:75], v[56:59]
    v_add_f32 v30, v30, v29
    v_mfma_f32_16x16x32_bf16 v[60:63], v[188:191], v[72:75], v[60:63]
    s_waitcnt vmcnt(0)
    v_perm_b32 v192, v228, v224, s30
    v_perm_b32 v193, v236, v232, s30
    v_perm_b32 v194, v244, v240, s30
    v_perm_b32 v195, v252, v248, s30
    v_perm_b32 v196, v228, v224, s90
    v_perm_b32 v197, v236, v232, s90
    v_perm_b32 v198, v244, v240, s90
    v_perm_b32 v199, v252, v248, s90
    v_mfma_f32_16x16x32_bf16 v[32:35], v[192:195], v[76:79], v[32:35]
    v_perm_b32 v200, v229, v225, s30
    v_perm_b32 v201, v237, v233, s30
    v_perm_b32 v202, v245, v241, s30
    v_perm_b32 v203, v253, v249, s30
    v_mfma_f32_16x16x32_bf16 v[36:39], v[196:199], v[76:79], v[36:39]
    v_perm_b32 v204, v229, v225, s90
    v_perm_b32 v205, v237, v233, s90
    v_perm_b32 v206, v245, v241, s90
    v_perm_b32 v207, v253, v249, s90
    v_mfma_f32_16x16x32_bf16 v[40:43], v[200:203], v[76:79], v[40:43]
    v_perm_b32 v208, v230, v226, s30
    v_perm_b32 v209, v238, v234, s30
    v_perm_b32 v210, v246, v242, s30
    v_perm_b32 v211, v254, v250, s30
    v_mfma_f32_16x16x32_bf16 v[44:47], v[204:207], v[76:79], v[44:47]
    v_perm_b32 v212, v230, v226, s90
    v_perm_b32 v213, v238, v234, s90
    v_perm_b32 v214, v246, v242, s90
    v_perm_b32 v215, v254, v250, s90
    v_mfma_f32_16x16x32_bf16 v[48:51], v[208:211], v[76:79], v[48:51]
    v_perm_b32 v216, v231, v227, s30
    v_perm_b32 v217, v239, v235, s30
    v_perm_b32 v218, v247, v243, s30
    v_perm_b32 v219, v255, v251, s30
    v_mfma_f32_16x16x32_bf16 v[52:55], v[212:215], v[76:79], v[52:55]
    v_perm_b32 v220, v231, v227, s90
    v_perm_b32 v221, v239, v235, s90
    v_perm_b32 v222, v247, v243, s90
    v_perm_b32 v223, v255, v251, s90
    v_mfma_f32_16x16x32_bf16 v[56:59], v[216:219], v[76:79], v[56:59]
    s_nop 0
    v_mfma_f32_16x16x32_bf16 v[60:63], v[220:223], v[76:79], v[60:63]
    s_cmp_eq_u32 s35, 0
    s_cbranch_scc1 L_to_35
    s_cmp_eq_u32 s35, 2
    s_cbranch_scc1 L_td_36
    s_branch L_tj_37
L_to_35:
    v_lshrrev_b32 v85, 3, v1
    v_and_b32 v84, 3, v85
    v_lshlrev_b32 v84, 3, v84
    v_lshrrev_b32 v85, 2, v85
    v_add_u32 v84, v84, v85
    s_lshl_b32 s29, s24, 7
    s_lshl_b32 s31, s20, 9
    s_add_u32 s29, s29, s31
    v_add_u32 v84, s29, v84
    v_lshlrev_b32 v84, 10, v84
    v_bfe_u32 v85, v1, 1, 2
    v_bfe_u32 v31, v1, 4, 1
    v_xor_b32 v85, v85, v31
    v_lshlrev_b32 v85, 5, v85
    v_and_b32 v31, 1, v1
    v_lshl_add_u32 v85, v31, 4, v85
    v_add_u32 v84, v84, v85
    s_lshl_b32 s29, s41, 7
    v_add_u32 v84, s29, v84
    v_xor_b32 v85, 64, v84
    s_lshl_b32 s100, s24, 14
    s_add_u32 s100, s100, 32768
    s_mov_b32 s92, s72
    s_mov_b32 s93, s73
    s_mov_b32 s94, 0x400000
    s_mov_b32 s95, 0x00020000
    s_add_u32 m0, s100, 0
    s_mov_b32 s96, 0
    buffer_load_dwordx4 v84, s[92:95], s96 offen nt lds
    s_add_u32 m0, s100, 1024
    s_mov_b32 s96, 2048
    buffer_load_dwordx4 v85, s[92:95], s96 offen nt lds
    s_add_u32 m0, s100, 2048
    s_mov_b32 s96, 4096
    buffer_load_dwordx4 v84, s[92:95], s96 offen nt lds
    s_add_u32 m0, s100, 3072
    s_mov_b32 s96, 6144
    buffer_load_dwordx4 v85, s[92:95], s96 offen nt lds
    s_add_u32 m0, s100, 4096
    s_mov_b32 s96, 32768
    buffer_load_dwordx4 v84, s[92:95], s96 offen nt lds
    s_add_u32 m0, s100, 5120
    s_mov_b32 s96, 34816
    buffer_load_dwordx4 v85, s[92:95], s96 offen nt lds
    s_add_u32 m0, s100, 6144
    s_mov_b32 s96, 36864
    buffer_load_dwordx4 v84, s[92:95], s96 offen nt lds
    s_add_u32 m0, s100, 7168
    s_mov_b32 s96, 38912
    buffer_load_dwordx4 v85, s[92:95], s96 offen nt lds
    s_branch L_tj_37
L_td_36:
    v_lshrrev_b32 v84, 3, v1
    s_mul_i32 s29, s20, 224
    s_lshl_b32 s31, s24, 6
    s_add_u32 s29, s29, s31
    v_add_u32 v84, s29, v84
    v_lshlrev_b32 v84, 10, v84
    v_bfe_u32 v85, v1, 1, 2
    v_bfe_u32 v31, v1, 4, 1
    v_xor_b32 v85, v85, v31
    v_lshlrev_b32 v85, 5, v85
    v_and_b32 v31, 1, v1
    v_lshl_add_u32 v85, v31, 4, v85
    v_add_u32 v84, v84, v85
    s_lshl_b32 s29, s41, 7
    v_add_u32 v84, s29, v84
    v_xor_b32 v85, 64, v84
    s_lshl_b32 s100, s24, 13
    s_add_u32 s100, s100, 32768
    s_mov_b32 s92, s80
    s_mov_b32 s93, s81
    s_mov_b32 s94, 0x1c0000
    s_mov_b32 s95, 0x00020000
    s_cmp_eq_u32 s24, 3
    s_cbranch_scc1 L_t3_39
    s_add_u32 m0, s100, 0
    s_mov_b32 s96, 0
    buffer_load_dwordx4 v84, s[92:95], s96 offen nt lds
    s_add_u32 m0, s100, 1024
    s_mov_b32 s96, 8192
    buffer_load_dwordx4 v85, s[92:95], s96 offen nt lds
    s_add_u32 m0, s100, 2048
    s_mov_b32 s96, 16384
    buffer_load_dwordx4 v84, s[92:95], s96 offen nt lds
    s_add_u32 m0, s100, 3072
    s_mov_b32 s96, 24576
    buffer_load_dwordx4 v85, s[92:95], s96 offen nt lds
    s_add_u32 m0, s100, 4096
    s_mov_b32 s96, 32768
    buffer_load_dwordx4 v84, s[92:95], s96 offen nt lds
    s_add_u32 m0, s100, 5120
    s_mov_b32 s96, 40960
    buffer_load_dwordx4 v85, s[92:95], s96 offen nt lds
    s_add_u32 m0, s100, 6144
    s_mov_b32 s96, 49152
    buffer_load_dwordx4 v84, s[92:95], s96 offen nt lds
    s_add_u32 m0, s100, 7168
    s_mov_b32 s96, 57344
    buffer_load_dwordx4 v85, s[92:95], s96 offen nt lds
    s_branch L_tj_37
L_t3_39:
    s_add_u32 m0, s100, 0
    s_mov_b32 s96, 0
    buffer_load_dwordx4 v84, s[92:95], s96 offen nt lds
    s_add_u32 m0, s100, 1024
    s_mov_b32 s96, 8192
    buffer_load_dwordx4 v85, s[92:95], s96 offen nt lds
    s_add_u32 m0, s100, 2048
    s_mov_b32 s96, 16384
    buffer_load_dwordx4 v84, s[92:95], s96 offen nt lds
    s_add_u32 m0, s100, 3072
    s_mov_b32 s96, 24576
    buffer_load_dwordx4 v85, s[92:95], s96 offen nt lds
L_tj_37:
    s_branch L_sjoin_22
L_cls_23:
    s_add_u32 m0, s101, 5120
    s_xor_b32 s96, s98, 10240
    buffer_load_dwordx4 v89, s[8:11], s96 offen nt lds
    s_add_u32 m0, s101, 6144
    s_xor_b32 s96, s98, 12288
    buffer_load_dwordx4 v90, s[8:11], s96 offen nt lds
    s_add_u32 m0, s101, 7168
    s_xor_b32 s96, s98, 14336
    s_waitcnt vmcnt(12)
    buffer_load_dwordx4 v91, s[8:11], s96 offen nt lds
    s_waitcnt vmcnt(10)
    ds_read_b128 a[0:3], v64 offset:0
    ds_read_b128 a[4:7], v65 offset:0
    ds_read_b128 a[8:11], v66 offset:0
    ds_read_b128 a[12:15], v67 offset:0
    s_add_u32 m0, s101, 8192
    s_xor_b32 s96, s98, 16384
    s_waitcnt vmcnt(12)
    buffer_load_dwordx4 v88, s[8:11], s96 offen nt lds
    s_add_u32 m0, s101, 9216
    s_xor_b32 s96, s98, 18432
    s_waitcnt vmcnt(12)
    buffer_load_dwordx4 v89, s[8:11], s96 offen nt lds
    s_add_u32 m0, s101, 10240
    s_xor_b32 s96, s98, 20480
    s_waitcnt vmcnt(12)
    buffer_load_dwordx4 v90, s[8:11], s96 offen nt lds
    s_add_u32 m0, s101, 11264
    s_xor_b32 s96, s98, 22528
    s_waitcnt vmcnt(12)
    buffer_load_dwordx4 v91, s[8:11], s96 offen nt lds
    s_waitcnt vmcnt(4)
    ds_read_b128 a[16:19], v64 offset:4096
    ds_read_b128 a[20:23], v65 offset:4096
    ds_read_b128 a[24:27], v66 offset:4096
    ds_read_b128 a[28:31], v67 offset:4096
    s_waitcnt vmcnt(11)
    s_barrier
    s_cmp_lg_u32 s24, 0
    s_cbranch_scc1 L_w0skip_40
    s_and_b32 s29, s20, 3
    s_lshl_b32 s29, s29, 6
    s_lshr_b32 s30, s20, 2
    s_lshl_b32 s30, s30, 2
    s_add_u32 s29, s29, s30
    s_mov_b64 exec, 1
    v_mov_b32 v84, s29
    v_mov_b32 v85, 1
    global_atomic_add v84, v85, s[84:85]
    s_mov_b64 exec, -1
L_w0skip_40:
    s_cmp_lg_u32 s24, 0
    s_cbranch_scc1 L_w0skip_41
    v_lshlrev_b32 v24, 16, v26
    v_and_b32 v25, 0xffff0000, v26
    v_lshlrev_b32 v26, 16, v27
    v_and_b32 v27, 0xffff0000, v27
L_w0skip_41:
    s_waitcnt vmcnt(7)
    v_lshrrev_b32 v28, 2, v2
    v_lshl_add_u32 v28, v3, 3, v28
    s_lshl_b32 s30, s24, 7
    v_add_u32 v28, s30, v28
    v_lshlrev_b32 v28, 5, v28
    v_add_u32 v28, 147456, v28
    v_and_b32 v29, 3, v2
    v_lshl_add_u32 v28, v29, 3, v28
    ds_read_b64_tr_b16 a[236:237], v28 offset:0
    ds_read_b64_tr_b16 a[238:239], v28 offset:128
    ds_read_b64_tr_b16 a[240:241], v28 offset:1024
    ds_read_b64_tr_b16 a[242:243], v28 offset:1152
    ds_read_b64_tr_b16 a[244:245], v28 offset:2048
    ds_read_b64_tr_b16 a[246:247], v28 offset:2176
    ds_read_b64_tr_b16 a[248:249], v28 offset:3072
    ds_read_b64_tr_b16 a[250:251], v28 offset:3200
    v_mov_b32 v32, 0x3f803f80
    v_mov_b32 v33, 0x3f803f80
    v_mov_b32 v34, 0x3f803f80
    v_mov_b32 v35, 0x3f803f80
    v_mov_b32 v36, 0x3f803f80
    v_mov_b32 v37, 0x3f803f80
    v_mov_b32 v38, 0x3f803f80
    v_mov_b32 v39, 0x3f803f80
    v_mov_b32 v40, 0x3f803f80
    v_mov_b32 v41, 0x3f803f80
    v_mov_b32 v42, 0x3f803f80
    v_mov_b32 v43, 0x3f803f80
    v_mov_b32 v44, 0x3f803f80
    v_mov_b32 v45, 0x3f803f80
    v_mov_b32 v46, 0x3f803f80
    v_mov_b32 v47, 0x3f803f80
    v_lshlrev_b32 v30, 10, v2
    v_lshl_add_u32 v30, v3, 4, v30
    s_lshl_b32 s29, s24, 8
    s_add_u32 s29, s29, 12288
    v_add_u32 v30, s29, v30
    s_mov_b64 exec, s[50:51]
    ds_read_b128 v[32:35], v30 offset:0
    ds_read_b128 v[36:39], v30 offset:64
    ds_read_b128 v[40:43], v30 offset:128
    ds_read_b128 v[44:47], v30 offset:192
    s_mov_b64 exec, -1
    s_waitcnt lgkmcnt(0)
    s_add_u32 m0, s101, 0
    s_xor_b32 s96, s98, 24576
    s_waitcnt vmcnt(6)
    buffer_load_dwordx4 v88, s[8:11], s96 offen nt lds
    s_waitcnt lgkmcnt(0)
    v_mfma_f32_16x16x32_bf16 v[48:51], v[32:35], a[236:239], 0
    v_mfma_f32_16x16x32_bf16 v[52:55], v[32:35], v[32:35], 0
    v_mfma_f32_16x16x32_bf16 v[48:51], v[36:39], a[240:243], v[48:51]
    v_mfma_f32_16x16x32_bf16 v[52:55], v[36:39], v[36:39], v[52:55]
    v_mfma_f32_16x16x32_bf16 v[48:51], v[40:43], a[244:247], v[48:51]
    v_mfma_f32_16x16x32_bf16 v[52:55], v[40:43], v[40:43], v[52:55]
    v_mfma_f32_16x16x32_bf16 v[48:51], v[44:47], a[248:251], v[48:51]
    v_mfma_f32_16x16x32_bf16 v[52:55], v[44:47], v[44:47], v[52:55]
    s_mov_b64 exec, s[62:63]
    s_nop 5
    ds_write_b32 v13, v48
    s_mov_b64 exec, s[54:55]
    ds_write_b32 v13, v49 offset:272
    ds_write_b32 v13, v50 offset:544
    ds_write_b32 v13, v51 offset:816
    s_mov_b64 exec, -1
    v_cndmask_b32 v28, v52, v53, s[42:43]
    v_cndmask_b32 v28, v28, v54, s[44:45]
    v_cndmask_b32 v28, v28, v55, s[46:47]
    s_mov_b64 exec, s[48:49]
    ds_write_b32 v15, v28 offset:10240
    s_mov_b64 exec, -1
    s_waitcnt lgkmcnt(0)
    s_barrier
    s_add_u32 m0, s101, 1024
    s_xor_b32 s96, s98, 26624
    s_waitcnt vmcnt(6)
    buffer_load_dwordx4 v89, s[8:11], s96 offen nt lds
    s_add_u32 m0, s101, 2048
    s_xor_b32 s96, s98, 28672
    s_waitcnt vmcnt(6)
    buffer_load_dwordx4 v90, s[8:11], s96 offen nt lds
    s_cmp_lg_u32 s24, 0
    s_cbranch_scc1 L_w0skip_42
    s_mov_b64 exec, s[54:55]
    ds_read_b128 v[68:71], v95 offset:10240
    ds_read_b128 v[72:75], v95 offset:10256
    ds_read_b128 v[32:35], v94 offset:0
    ds_read_b128 v[36:39], v94 offset:2560
    ds_read_b128 v[40:43], v94 offset:5120
    ds_read_b128 v[44:47], v94 offset:7680
    v_lshrrev_b32 v28, 4, v1
    v_lshlrev_b32 v28, 5, v28
    v_and_b32 v29, 1, v1
    v_lshl_add_u32 v28, v29, 4, v28
    ds_read_b128 v[48:51], v28 offset:2176
    ds_read_b128 v[52:55], v28 offset:4736
    ds_read_b128 v[56:59], v28 offset:7296
    ds_read_b128 v[60:63], v28 offset:9856
    s_waitcnt lgkmcnt(0)
    v_pk_add_f32 v[48:49], v[48:49], v[52:53]
    v_pk_add_f32 v[50:51], v[50:51], v[54:55]
    v_pk_add_f32 v[56:57], v[56:57], v[60:61]
    v_pk_add_f32 v[58:59], v[58:59], v[62:63]
    v_pk_add_f32 v[48:49], v[48:49], v[56:57]
    v_pk_add_f32 v[50:51], v[50:51], v[58:59]
    v_accvgpr_write_b32 a232, v48
    v_accvgpr_write_b32 a233, v49
    v_accvgpr_write_b32 a234, v50
    v_accvgpr_write_b32 a235, v51
    v_add_f32 v68, v68, v69
    v_add_f32 v72, v72, v73
    v_add_f32 v70, v70, v71
    v_add_f32 v74, v74, v75
    v_add_f32 v68, v68, v70
    v_add_f32 v72, v72, v74
    v_mul_f32 v76, 0x3b000000, v68
    v_mul_f32 v77, 0x3b000000, v72
    v_fma_f32 v77, -v76, v76, v77
    v_max_f32 v77, 0, v77
    v_add_f32 v77, 0x3727c5ac, v77
    v_rsq_f32 v77, v77
    v_pk_add_f32 v[32:33], v[32:33], v[36:37]
    v_pk_add_f32 v[34:35], v[34:35], v[38:39]
    v_pk_add_f32 v[40:41], v[40:41], v[44:45]
    v_pk_add_f32 v[42:43], v[42:43], v[46:47]
    v_pk_add_f32 v[32:33], v[32:33], v[40:41]
    v_pk_add_f32 v[34:35], v[34:35], v[42:43]
    v_fma_f32 v32, -v76, v48, v32
    v_fma_f32 v33, -v76, v49, v33
    v_fma_f32 v34, -v76, v50, v34
    v_fma_f32 v35, -v76, v51, v35
    v_mul_f32 v32, v77, v32
    v_mul_f32 v33, v77, v33
    v_mul_f32 v34, v77, v34
    v_mul_f32 v35, v77, v35
    v_cvt_pk_bf16_f32 v28, v32, v33
    v_cvt_pk_bf16_f32 v29, v34, v35
    buffer_store_dwordx2 v[28:29], v93, s[4:7], s32 offen sc1
    s_mov_b64 exec, -1
L_w0skip_42:
    s_add_u32 m0, s101, 3072
    s_xor_b32 s96, s98, 30720
    s_waitcnt vmcnt(6)
    buffer_load_dwordx4 v91, s[8:11], s96 offen nt lds
    s_waitcnt vmcnt(4)
    ds_read_b128 a[32:35], v64 offset:8192
    ds_read_b128 a[36:39], v65 offset:8192
    ds_read_b128 a[40:43], v66 offset:8192
    ds_read_b128 a[44:47], v67 offset:8192
    s_waitcnt lgkmcnt(0)
    s_add_u32 m0, s101, 4096
    s_xor_b32 s96, s98, 1024
    s_waitcnt vmcnt(6)
    buffer_load_dwordx4 v88, s[8:11], s96 offen nt lds
    s_add_u32 m0, s101, 5120
    s_xor_b32 s96, s98, 3072
    s_waitcnt vmcnt(6)
    buffer_load_dwordx4 v89, s[8:11], s96 offen nt lds
    s_add_u32 m0, s101, 6144
    s_xor_b32 s96, s98, 5120
    s_waitcnt vmcnt(6)
    buffer_load_dwordx4 v90, s[8:11], s96 offen nt lds
    s_add_u32 m0, s101, 7168
    s_xor_b32 s96, s98, 7168
    s_waitcnt vmcnt(6)
    buffer_load_dwordx4 v91, s[8:11], s96 offen nt lds
    s_waitcnt vmcnt(4)
    ds_read_b128 a[48:51], v64 offset:0
    ds_read_b128 a[52:55], v65 offset:0
    ds_read_b128 a[56:59], v66 offset:0
    ds_read_b128 a[60:63], v67 offset:0
    s_waitcnt lgkmcnt(0)
    s_add_u32 m0, s101, 8192
    s_xor_b32 s96, s98, 9216
    s_waitcnt vmcnt(6)
    buffer_load_dwordx4 v88, s[8:11], s96 offen nt lds
    s_add_u32 m0, s101, 9216
    s_xor_b32 s96, s98, 11264
    s_waitcnt vmcnt(6)
    buffer_load_dwordx4 v89, s[8:11], s96 offen nt lds
    s_add_u32 m0, s101, 10240
    s_xor_b32 s96, s98, 13312
    s_waitcnt vmcnt(6)
    buffer_load_dwordx4 v90, s[8:11], s96 offen nt lds
    s_add_u32 m0, s101, 11264
    s_xor_b32 s96, s98, 15360
    s_waitcnt vmcnt(6)
    buffer_load_dwordx4 v91, s[8:11], s96 offen nt lds
    s_waitcnt vmcnt(4)
    ds_read_b128 a[64:67], v64 offset:4096
    ds_read_b128 a[68:71], v65 offset:4096
    ds_read_b128 a[72:75], v66 offset:4096
    ds_read_b128 a[76:79], v67 offset:4096
    s_waitcnt lgkmcnt(0)
    s_add_u32 m0, s101, 0
    s_xor_b32 s96, s98, 17408
    s_waitcnt vmcnt(6)
    buffer_load_dwordx4 v88, s[8:11], s96 offen nt lds
    s_add_u32 m0, s101, 1024
    s_xor_b32 s96, s98, 19456
    s_waitcnt vmcnt(6)
    buffer_load_dwordx4 v89, s[8:11], s96 offen nt lds
    s_add_u32 m0, s101, 2048
    s_xor_b32 s96, s98, 21504
    s_waitcnt vmcnt(6)
    buffer_load_dwordx4 v90, s[8:11], s96 offen nt lds
    s_add_u32 m0, s101, 3072
    s_xor_b32 s96, s98, 23552
    s_waitcnt vmcnt(6)
    buffer_load_dwordx4 v91, s[8:11], s96 offen nt lds
    s_waitcnt vmcnt(4)
    ds_read_b128 a[80:83], v64 offset:8192
    ds_read_b128 a[84:87], v65 offset:8192
    ds_read_b128 a[88:91], v66 offset:8192
    ds_read_b128 a[92:95], v67 offset:8192
    s_waitcnt lgkmcnt(0)
    s_add_u32 m0, s101, 4096
    s_xor_b32 s96, s98, 25600
    s_waitcnt vmcnt(6)
    buffer_load_dwordx4 v88, s[8:11], s96 offen nt lds
    s_add_u32 m0, s101, 5120
    s_xor_b32 s96, s98, 27648
    s_waitcnt vmcnt(6)
    buffer_load_dwordx4 v89, s[8:11], s96 offen nt lds
    s_add_u32 m0, s101, 6144
    s_xor_b32 s96, s98, 29696
    s_waitcnt vmcnt(6)
    buffer_load_dwordx4 v90, s[8:11], s96 offen nt lds
    s_add_u32 m0, s101, 7168
    s_xor_b32 s96, s98, 31744
    s_waitcnt vmcnt(6)
    buffer_load_dwordx4 v91, s[8:11], s96 offen nt lds
    s_waitcnt vmcnt(4)
    ds_read_b128 a[96:99], v64 offset:0
    ds_read_b128 a[100:103], v65 offset:0
    ds_read_b128 a[104:107], v66 offset:0
    ds_read_b128 a[108:111], v67 offset:0
    s_cmp_lg_u32 s24, 0
    s_cbranch_scc1 L_w0skip_43
    v_and_b32 v84, 3, v1
    v_lshlrev_b32 v84, 6, v84
    v_bfe_u32 v85, v1, 2, 1
    v_lshl_add_u32 v84, v85, 2, v84
    s_mov_b64 exec, 0xff
    global_load_dword v85, v84, s[84:85] sc1
    s_mov_b64 exec, -1
L_w0skip_43:
    s_xor_b32 s96, s99, 0
    s_waitcnt vmcnt(6)
    buffer_load_dwordx4 v[128:131], v0, s[12:15], s96 offen nt
    s_xor_b32 s96, s99, 256
    s_waitcnt vmcnt(6)
    buffer_load_dwordx4 v[132:135], v0, s[12:15], s96 offen nt
    s_xor_b32 s96, s99, 512
    s_waitcnt vmcnt(6)
    buffer_load_dwordx4 v[136:139], v0, s[12:15], s96 offen nt
    s_xor_b32 s96, s99, 768
    s_waitcnt vmcnt(6)
    buffer_load_dwordx4 v[140:143], v0, s[12:15], s96 offen nt
    s_waitcnt vmcnt(4)
    ds_read_b128 a[112:115], v64 offset:4096
    ds_read_b128 a[116:119], v65 offset:4096
    ds_read_b128 a[120:123], v66 offset:4096
    ds_read_b128 a[124:127], v67 offset:4096
    s_xor_b32 s96, s99, 1024
    s_waitcnt vmcnt(6)
    buffer_load_dwordx4 v[144:147], v0, s[12:15], s96 offen nt
    s_xor_b32 s96, s99, 1280
    s_waitcnt vmcnt(6)
    buffer_load_dwordx4 v[148:151], v0, s[12:15], s96 offen nt
    s_xor_b32 s96, s99, 1536
    s_waitcnt vmcnt(6)
    buffer_load_dwordx4 v[152:155], v0, s[12:15], s96 offen nt
    s_cmp_lg_u32 s24, 0
    s_cbranch_scc1 L_w0skip_44
    s_waitcnt vmcnt(7)
    s_mov_b64 exec, 0xff
    v_cmp_gt_u32 vcc, 32, v85
    s_cbranch_vccz L_cntd_46
    s_mov_b32 s28, s27
L_cnt_45:
    s_sleep 8
    global_load_dword v85, v84, s[84:85] sc1
    s_waitcnt vmcnt(0)
    v_cmp_gt_u32 vcc, 32, v85
    s_cbranch_vccz L_cntd_46
    s_sub_u32 s28, s28, 1
    s_cbranch_scc0 L_cnt_45
    s_mov_b32 s27, 0
L_cntd_46:
    s_mov_b64 exec, -1
    v_lshlrev_b32 v28, 5, v1
    s_lshl_b32 s29, s20, 2
    v_add_u32 v28, s29, v28
    s_mov_b64 exec, s[54:55]
    s_mov_b32 s30, 1507328
    buffer_load_dword v40, v28, s[4:7], s30 offen sc1
    s_mov_b64 exec, -1
    s_lshl_b32 s29, s22, 5
    v_lshlrev_b32 v86, 4, v1
    v_lshrrev_b32 v87, 1, v1
    v_lshlrev_b32 v87, 8, v87
    v_and_b32 v29, 1, v1
    v_lshl_add_u32 v87, v29, 4, v87
    v_add_u32 v87, s29, v87
    buffer_load_dwordx4 v[32:35], v87, s[4:7], s32 offen sc1
L_w0skip_44:
    s_xor_b32 s96, s99, 1792
    s_waitcnt vmcnt(6)
    buffer_load_dwordx4 v[156:159], v0, s[12:15], s96 offen nt
    s_xor_b32 s96, s99, 8192
    s_waitcnt vmcnt(6)
    buffer_load_dwordx4 v[160:163], v0, s[12:15], s96 offen nt
    s_xor_b32 s96, s99, 8448
    s_waitcnt vmcnt(6)
    buffer_load_dwordx4 v[164:167], v0, s[12:15], s96 offen nt
    s_xor_b32 s96, s99, 8704
    s_waitcnt vmcnt(6)
    buffer_load_dwordx4 v[168:171], v0, s[12:15], s96 offen nt
    s_xor_b32 s96, s99, 8960
    s_waitcnt vmcnt(6)
    buffer_load_dwordx4 v[172:175], v0, s[12:15], s96 offen nt
    s_xor_b32 s96, s99, 9216
    s_waitcnt vmcnt(6)
    buffer_load_dwordx4 v[176:179], v0, s[12:15], s96 offen nt
    s_xor_b32 s96, s99, 9472
    s_waitcnt vmcnt(6)
    buffer_load_dwordx4 v[180:183], v0, s[12:15], s96 offen nt
    s_cmp_lg_u32 s24, 0
    s_cbranch_scc1 L_w0skip_47
    s_waitcnt vmcnt(7)
    v_max3_u32 v28, v32, v33, v34
    v_max_u32 v28, v28, v35
    v_cmp_eq_u32 vcc, -1, v28
    s_cbranch_vccz L_qok_48
    s_lshl_b32 s29, s22, 5
    v_lshlrev_b32 v86, 4, v1
    v_lshrrev_b32 v87, 1, v1
    v_lshlrev_b32 v87, 8, v87
    v_and_b32 v29, 1, v1
    v_lshl_add_u32 v87, v29, 4, v87
    v_add_u32 v87, s29, v87
    s_mov_b32 s28, s27
L_pq0_49:
    buffer_load_dwordx4 v[32:35], v87, s[4:7], s32 offen sc1
    s_waitcnt vmcnt(0)
    v_max3_u32 v28, v32, v33, v34
    v_max_u32 v28, v28, v35
    v_cmp_eq_u32 vcc, -1, v28
    s_cbranch_vccz L_pq0d_50
    s_sub_u32 s28, s28, 1
    s_cbranch_scc0 L_pq0_49
    s_mov_b32 s27, 0
L_pq0d_50:
L_qok_48:
    ds_write_b128 v86, v[32:35] offset:21248
    s_getreg_b32 s29, hwreg(HW_REG_XCC_ID, 0, 4)
    s_mov_b64 exec, s[54:55]
    v_cmp_ne_u32 vcc, s29, v40
    s_mov_b64 exec, -1
    s_cmp_eq_u64 vcc, 0
    s_cselect_b32 s26, 1, 0
    v_mov_b32 v28, s26
    v_mov_b32 v29, 0
    ds_write_b32 v29, v28 offset:22272
L_w0skip_47:
    s_xor_b32 s96, s99, 9728
    s_waitcnt vmcnt(6)
    buffer_load_dwordx4 v[184:187], v0, s[12:15], s96 offen nt
    s_xor_b32 s96, s99, 9984
    s_waitcnt vmcnt(6)
    buffer_load_dwordx4 v[188:191], v0, s[12:15], s96 offen nt
    s_xor_b32 s96, s99, 16384
    s_waitcnt vmcnt(6)
    buffer_load_dwordx4 v[192:195], v0, s[12:15], s96 offen nt
    s_xor_b32 s96, s99, 16640
    s_waitcnt vmcnt(6)
    buffer_load_dwordx4 v[196:199], v0, s[12:15], s96 offen nt
    s_xor_b32 s96, s99, 16896
    s_waitcnt vmcnt(6)
    buffer_load_dwordx4 v[200:203], v0, s[12:15], s96 offen nt
    s_xor_b32 s96, s99, 17152
    s_waitcnt vmcnt(6)
    buffer_load_dwordx4 v[204:207], v0, s[12:15], s96 offen nt
    s_waitcnt lgkmcnt(0)
    s_barrier
    v_and_b32 v28, 3, v2
    v_lshlrev_b32 v28, 8, v28
    v_lshl_add_u32 v28, v3, 4, v28
    ds_read_b128 v[64:67], v28 offset:21248
    ds_read_b128 v[68:71], v28 offset:21312
    ds_read_b128 v[72:75], v28 offset:21376
    ds_read_b128 v[76:79], v28 offset:21440
    v_mov_b32 v29, 0
    ds_read_b32 v30, v29 offset:22272
    s_xor_b32 s96, s99, 17408
    s_waitcnt vmcnt(15)
    buffer_load_dwordx4 v[208:211], v0, s[12:15], s96 offen nt
    s_xor_b32 s96, s99, 17664
    s_waitcnt vmcnt(15)
    buffer_load_dwordx4 v[212:215], v0, s[12:15], s96 offen nt
    s_xor_b32 s96, s99, 17920
    s_waitcnt vmcnt(15)
    buffer_load_dwordx4 v[216:219], v0, s[12:15], s96 offen nt
    s_xor_b32 s96, s99, 18176
    s_waitcnt vmcnt(15)
    buffer_load_dwordx4 v[220:223], v0, s[12:15], s96 offen nt
    s_xor_b32 s96, s99, 24576
    s_waitcnt vmcnt(15)
    buffer_load_dwordx4 v[224:227], v0, s[12:15], s96 offen nt
    s_xor_b32 s96, s99, 24832
    s_waitcnt vmcnt(15)
    buffer_load_dwordx4 v[228:231], v0, s[12:15], s96 offen nt
    s_xor_b32 s96, s99, 25088
    s_waitcnt vmcnt(15)
    buffer_load_dwordx4 v[232:235], v0, s[12:15], s96 offen nt
    s_xor_b32 s96, s99, 25344
    s_waitcnt vmcnt(15)
    buffer_load_dwordx4 v[236:239], v0, s[12:15], s96 offen nt
    s_xor_b32 s96, s99, 25600
    s_waitcnt vmcnt(15)
    buffer_load_dwordx4 v[240:243], v0, s[12:15], s96 offen nt
    s_xor_b32 s96, s99, 25856
    s_waitcnt vmcnt(15)
    buffer_load_dwordx4 v[244:247], v0, s[12:15], s96 offen nt
    s_waitcnt lgkmcnt(0)
    v_readfirstlane_b32 s26, v30
    v_mfma_f32_16x16x32_bf16 v[32:35], a[0:3], v[64:67], 0
    v_mfma_f32_16x16x32_bf16 v[32:35], a[4:7], v[68:71], v[32:35]
    v_mfma_f32_16x16x32_bf16 v[32:35], a[8:11], v[72:75], v[32:35]
    v_mfma_f32_16x16x32_bf16 v[32:35], a[12:15], v[76:79], v[32:35]
    v_mfma_f32_16x16x32_bf16 v[36:39], a[16:19], v[64:67], 0
    v_mfma_f32_16x16x32_bf16 v[36:39], a[20:23], v[68:71], v[36:39]
    v_mfma_f32_16x16x32_bf16 v[36:39], a[24:27], v[72:75], v[36:39]
    v_mfma_f32_16x16x32_bf16 v[36:39], a[28:31], v[76:79], v[36:39]
    s_xor_b32 s96, s99, 26112
    s_waitcnt vmcnt(15)
    buffer_load_dwordx4 v[248:251], v0, s[12:15], s96 offen nt
    v_mfma_f32_16x16x32_bf16 v[40:43], a[32:35], v[64:67], 0
    v_mfma_f32_16x16x32_bf16 v[40:43], a[36:39], v[68:71], v[40:43]
    v_mfma_f32_16x16x32_bf16 v[40:43], a[40:43], v[72:75], v[40:43]
    v_mfma_f32_16x16x32_bf16 v[40:43], a[44:47], v[76:79], v[40:43]
    v_mfma_f32_16x16x32_bf16 v[44:47], a[48:51], v[64:67], 0
    v_mul_f32_dpp v80, v32, v17 quad_perm:[0,1,2,3] row_mask:0xf bank_mask:0x1
    v_mfma_f32_16x16x32_bf16 v[44:47], a[52:55], v[68:71], v[44:47]
    v_mul_f32_dpp v81, v33, v17 quad_perm:[0,1,2,3] row_mask:0xf bank_mask:0x1
    v_mfma_f32_16x16x32_bf16 v[44:47], a[56:59], v[72:75], v[44:47]
    v_mul_f32_dpp v82, v34, v17 quad_perm:[0,1,2,3] row_mask:0xf bank_mask:0x1
    v_mfma_f32_16x16x32_bf16 v[44:47], a[60:63], v[76:79], v[44:47]
    v_mul_f32_dpp v83, v35, v17 quad_perm:[0,1,2,3] row_mask:0xf bank_mask:0x1
    s_xor_b32 s96, s99, 26368
    s_waitcnt vmcnt(15)
    buffer_load_dwordx4 v[252:255], v0, s[12:15], s96 offen nt
    v_mfma_f32_16x16x32_bf16 v[48:51], a[64:67], v[64:67], 0
    v_mul_f32_dpp v80, v36, v17 quad_perm:[0,1,2,3] row_mask:0xf bank_mask:0x2
    v_mfma_f32_16x16x32_bf16 v[48:51], a[68:71], v[68:71], v[48:51]
    v_mul_f32_dpp v81, v37, v17 quad_perm:[0,1,2,3] row_mask:0xf bank_mask:0x2
    v_mfma_f32_16x16x32_bf16 v[48:51], a[72:75], v[72:75], v[48:51]
    v_mul_f32_dpp v82, v38, v17 quad_perm:[0,1,2,3] row_mask:0xf bank_mask:0x2
    v_mfma_f32_16x16x32_bf16 v[48:51], a[76:79], v[76:79], v[48:51]
    v_mul_f32_dpp v83, v39, v17 quad_perm:[0,1,2,3] row_mask:0xf bank_mask:0x2
    v_mfma_f32_16x16x32_bf16 v[52:55], a[80:83], v[64:67], 0
    v_mul_f32_dpp v80, v40, v17 quad_perm:[0,1,2,3] row_mask:0xf bank_mask:0x4
    v_mfma_f32_16x16x32_bf16 v[52:55], a[84:87], v[68:71], v[52:55]
    v_mul_f32_dpp v81, v41, v17 quad_perm:[0,1,2,3] row_mask:0xf bank_mask:0x4
    v_mfma_f32_16x16x32_bf16 v[52:55], a[88:91], v[72:75], v[52:55]
    v_mul_f32_dpp v82, v42, v17 quad_perm:[0,1,2,3] row_mask:0xf bank_mask:0x4
    v_mfma_f32_16x16x32_bf16 v[52:55], a[92:95], v[76:79], v[52:55]
    v_mul_f32_dpp v83, v43, v17 quad_perm:[0,1,2,3] row_mask:0xf bank_mask:0x4
    v_mfma_f32_16x16x32_bf16 v[56:59], a[96:99], v[64:67], 0
    v_mul_f32_dpp v80, v44, v17 quad_perm:[0,1,2,3] row_mask:0xf bank_mask:0x8
    v_mfma_f32_16x16x32_bf16 v[56:59], a[100:103], v[68:71], v[56:59]
    v_mul_f32_dpp v81, v45, v17 quad_perm:[0,1,2,3] row_mask:0xf bank_mask:0x8
    v_mfma_f32_16x16x32_bf16 v[56:59], a[104:107], v[72:75], v[56:59]
    v_mul_f32_dpp v82, v46, v17 quad_perm:[0,1,2,3] row_mask:0xf bank_mask:0x8
    v_mfma_f32_16x16x32_bf16 v[56:59], a[108:111], v[76:79], v[56:59]
    v_mul_f32_dpp v83, v47, v17 quad_perm:[0,1,2,3] row_mask:0xf bank_mask:0x8
    v_mfma_f32_16x16x32_bf16 v[60:63], a[112:115], v[64:67], 0
    v_mul_f32_dpp v84, v48, v17 quad_perm:[0,1,2,3] row_mask:0xf bank_mask:0x1
    v_mfma_f32_16x16x32_bf16 v[60:63], a[116:119], v[68:71], v[60:63]
    v_mul_f32_dpp v85, v49, v17 quad_perm:[0,1,2,3] row_mask:0xf bank_mask:0x1
    v_mfma_f32_16x16x32_bf16 v[60:63], a[120:123], v[72:75], v[60:63]
    v_mul_f32_dpp v86, v50, v17 quad_perm:[0,1,2,3] row_mask:0xf bank_mask:0x1
    v_mfma_f32_16x16x32_bf16 v[60:63], a[124:127], v[76:79], v[60:63]
    v_mul_f32_dpp v87, v51, v17 quad_perm:[0,1,2,3] row_mask:0xf bank_mask:0x1
    v_mul_f32_dpp v84, v52, v17 quad_perm:[0,1,2,3] row_mask:0xf bank_mask:0x2
    v_mul_f32_dpp v85, v53, v17 quad_perm:[0,1,2,3] row_mask:0xf bank_mask:0x2
    v_mul_f32_dpp v86, v54, v17 quad_perm:[0,1,2,3] row_mask:0xf bank_mask:0x2
    v_mul_f32_dpp v87, v55, v17 quad_perm:[0,1,2,3] row_mask:0xf bank_mask:0x2
    v_mul_f32_dpp v84, v56, v17 quad_perm:[0,1,2,3] row_mask:0xf bank_mask:0x4
    v_mul_f32_dpp v85, v57, v17 quad_perm:[0,1,2,3] row_mask:0xf bank_mask:0x4
    v_mul_f32_dpp v86, v58, v17 quad_perm:[0,1,2,3] row_mask:0xf bank_mask:0x4
    v_mul_f32_dpp v87, v59, v17 quad_perm:[0,1,2,3] row_mask:0xf bank_mask:0x4
    v_mul_f32_dpp v84, v60, v17 quad_perm:[0,1,2,3] row_mask:0xf bank_mask:0x8
    v_mul_f32_dpp v85, v61, v17 quad_perm:[0,1,2,3] row_mask:0xf bank_mask:0x8
    v_mul_f32_dpp v86, v62, v17 quad_perm:[0,1,2,3] row_mask:0xf bank_mask:0x8
    v_mul_f32_dpp v87, v63, v17 quad_perm:[0,1,2,3] row_mask:0xf bank_mask:0x8
    v_max3_f32 v28, v80, v81, v82
    v_max3_f32 v29, v83, v84, v85
    v_max3_f32 v28, v28, v86, v87
    v_max_f32 v28, v28, v29
    s_nop 1
    v_max_f32_dpp v28, v28, v28 row_ror:4 row_mask:0xf bank_mask:0xf
    s_nop 1
    v_max_f32_dpp v28, v28, v28 row_ror:8 row_mask:0xf bank_mask:0xf
    v_mov_b32 v29, v28
    s_nop 1
    v_permlane16_swap_b32 v28, v29
    v_max_f32 v28, v28, v29
    v_mov_b32 v29, v28
    s_nop 1
    v_permlane32_swap_b32 v28, v29
    v_max_f32 v28, v28, v29
    v_pk_add_f32 v[80:81], v[80:81], v[28:29] op_sel_hi:[1,0] neg_lo:[0,1] neg_hi:[0,1]
    v_pk_add_f32 v[82:83], v[82:83], v[28:29] op_sel_hi:[1,0] neg_lo:[0,1] neg_hi:[0,1]
    v_pk_add_f32 v[84:85], v[84:85], v[28:29] op_sel_hi:[1,0] neg_lo:[0,1] neg_hi:[0,1]
    v_pk_add_f32 v[86:87], v[86:87], v[28:29] op_sel_hi:[1,0] neg_lo:[0,1] neg_hi:[0,1]
    v_exp_f32 v80, v80
    v_exp_f32 v81, v81
    v_exp_f32 v82, v82
    v_exp_f32 v83, v83
    v_exp_f32 v84, v84
    v_exp_f32 v85, v85
    v_exp_f32 v86, v86
    v_exp_f32 v87, v87
    v_cvt_pk_bf16_f32 v88, v80, v81
    v_cvt_pk_bf16_f32 v89, v82, v83
    v_cvt_pk_bf16_f32 v90, v84, v85
    v_cvt_pk_bf16_f32 v91, v86, v87
    s_mov_b32 s30, 0x05040100
    s_mov_b32 s90, 0x07060302
    s_waitcnt vmcnt(24)
    v_perm_b32 v96, v132, v128, s30
    v_perm_b32 v97, v140, v136, s30
    v_perm_b32 v98, v148, v144, s30
    v_perm_b32 v99, v156, v152, s30
    v_perm_b32 v100, v132, v128, s90
    v_perm_b32 v101, v140, v136, s90
    v_perm_b32 v102, v148, v144, s90
    v_perm_b32 v103, v156, v152, s90
    v_mfma_f32_16x16x32_bf16 v[32:35], v[96:99], v[88:91], 0
    v_perm_b32 v104, v133, v129, s30
    v_perm_b32 v105, v141, v137, s30
    v_perm_b32 v106, v149, v145, s30
    v_perm_b32 v107, v157, v153, s30
    v_mov_b32_dpp v68, v88 row_shl:4 row_mask:0xf bank_mask:0xf
    v_mov_b32_dpp v69, v89 row_shl:4 row_mask:0xf bank_mask:0xf
    v_mfma_f32_16x16x32_bf16 v[36:39], v[100:103], v[88:91], 0
    v_perm_b32 v108, v133, v129, s90
    v_perm_b32 v109, v141, v137, s90
    v_perm_b32 v110, v149, v145, s90
    v_perm_b32 v111, v157, v153, s90
    v_mov_b32_dpp v70, v90 row_shl:4 row_mask:0xf bank_mask:0xf
    v_mov_b32_dpp v71, v91 row_shl:4 row_mask:0xf bank_mask:0xf
    v_mfma_f32_16x16x32_bf16 v[40:43], v[104:107], v[88:91], 0
    v_perm_b32 v112, v134, v130, s30
    v_perm_b32 v113, v142, v138, s30
    v_perm_b32 v114, v150, v146, s30
    v_perm_b32 v115, v158, v154, s30
    v_mov_b32_dpp v72, v88 row_shl:8 row_mask:0xf bank_mask:0xf
    v_mov_b32_dpp v73, v89 row_shl:8 row_mask:0xf bank_mask:0xf
    v_mfma_f32_16x16x32_bf16 v[44:47], v[108:111], v[88:91], 0
    v_perm_b32 v116, v134, v130, s90
    v_perm_b32 v117, v142, v138, s90
    v_perm_b32 v118, v150, v146, s90
    v_perm_b32 v119, v158, v154, s90
    v_mov_b32_dpp v74, v90 row_shl:8 row_mask:0xf bank_mask:0xf
    v_mov_b32_dpp v75, v91 row_shl:8 row_mask:0xf bank_mask:0xf
    v_mfma_f32_16x16x32_bf16 v[48:51], v[112:115], v[88:91], 0
    v_perm_b32 v120, v135, v131, s30
    v_perm_b32 v121, v143, v139, s30
    v_perm_b32 v122, v151, v147, s30
    v_perm_b32 v123, v159, v155, s30
    v_mov_b32_dpp v76, v88 row_shl:12 row_mask:0xf bank_mask:0xf
    v_mfma_f32_16x16x32_bf16 v[52:55], v[116:119], v[88:91], 0
    v_perm_b32 v124, v135, v131, s90
    v_perm_b32 v125, v143, v139, s90
    v_perm_b32 v126, v151, v147, s90
    v_perm_b32 v127, v159, v155, s90
    v_mov_b32_dpp v77, v89 row_shl:12 row_mask:0xf bank_mask:0xf
    v_mfma_f32_16x16x32_bf16 v[56:59], v[120:123], v[88:91], 0
    v_mov_b32_dpp v78, v90 row_shl:12 row_mask:0xf bank_mask:0xf
    v_mfma_f32_16x16x32_bf16 v[60:63], v[124:127], v[88:91], 0
    v_mov_b32_dpp v79, v91 row_shl:12 row_mask:0xf bank_mask:0xf
    s_waitcnt vmcnt(16)
    v_perm_b32 v128, v164, v160, s30
    v_perm_b32 v129, v172, v168, s30
    v_perm_b32 v130, v180, v176, s30
    v_perm_b32 v131, v188, v184, s30
    v_perm_b32 v132, v164, v160, s90
    v_perm_b32 v133, v172, v168, s90
    v_perm_b32 v134, v180, v176, s90
    v_perm_b32 v135, v188, v184, s90
    v_mfma_f32_16x16x32_bf16 v[32:35], v[128:131], v[68:71], v[32:35]
    v_perm_b32 v136, v165, v161, s30
    v_perm_b32 v137, v173, v169, s30
    v_perm_b32 v138, v181, v177, s30
    v_perm_b32 v139, v189, v185, s30
    v_add_f32 v30, v80, v81
    v_mfma_f32_16x16x32_bf16 v[36:39], v[132:135], v[68:71], v[36:39]
    v_perm_b32 v140, v165, v161, s90
    v_perm_b32 v141, v173, v169, s90
    v_perm_b32 v142, v181, v177, s90
    v_perm_b32 v143, v189, v185, s90
    v_add_f32 v29, v82, v83
    v_mfma_f32_16x16x32_bf16 v[40:43], v[136:139], v[68:71], v[40:43]
    v_perm_b32 v144, v166, v162, s30
    v_perm_b32 v145, v174, v170, s30
    v_perm_b32 v146, v182, v178, s30
    v_perm_b32 v147, v190, v186, s30
    v_add_f32 v30, v30, v84
    v_mfma_f32_16x16x32_bf16 v[44:47], v[140:143], v[68:71], v[44:47]
    v_perm_b32 v148, v166, v162, s90
    v_perm_b32 v149, v174, v170, s90
    v_perm_b32 v150, v182, v178, s90
    v_perm_b32 v151, v190, v186, s90
    v_add_f32 v29, v29, v85
    v_mfma_f32_16x16x32_bf16 v[48:51], v[144:147], v[68:71], v[48:51]
    v_perm_b32 v152, v167, v163, s30
    v_perm_b32 v153, v175, v171, s30
    v_perm_b32 v154, v183, v179, s30
    v_perm_b32 v155, v191, v187, s30
    v_add_f32 v30, v30, v86
    v_mfma_f32_16x16x32_bf16 v[52:55], v[148:151], v[68:71], v[52:55]
    v_perm_b32 v156, v167, v163, s90
    v_perm_b32 v157, v175, v171, s90
    v_perm_b32 v158, v183, v179, s90
    v_perm_b32 v159, v191, v187, s90
    v_add_f32 v29, v29, v87
    v_mfma_f32_16x16x32_bf16 v[56:59], v[152:155], v[68:71], v[56:59]
    v_add_f32 v30, v30, v29
    v_mfma_f32_16x16x32_bf16 v[60:63], v[156:159], v[68:71], v[60:63]
    s_nop 0
    v_add_f32_dpp v30, v30, v30 row_ror:4 row_mask:0xf bank_mask:0xf
    s_waitcnt vmcnt(8)
    v_perm_b32 v160, v196, v192, s30
    v_perm_b32 v161, v204, v200, s30
    v_perm_b32 v162, v212, v208, s30
    v_perm_b32 v163, v220, v216, s30
    v_perm_b32 v164, v196, v192, s90
    v_perm_b32 v165, v204, v200, s90
    v_perm_b32 v166, v212, v208, s90
    v_perm_b32 v167, v220, v216, s90
    v_mfma_f32_16x16x32_bf16 v[32:35], v[160:163], v[72:75], v[32:35]
    v_perm_b32 v168, v197, v193, s30
    v_perm_b32 v169, v205, v201, s30
    v_perm_b32 v170, v213, v209, s30
    v_perm_b32 v171, v221, v217, s30
    v_add_f32_dpp v30, v30, v30 row_ror:8 row_mask:0xf bank_mask:0xf
    v_mfma_f32_16x16x32_bf16 v[36:39], v[164:167], v[72:75], v[36:39]
    v_perm_b32 v172, v197, v193, s90
    v_perm_b32 v173, v205, v201, s90
    v_perm_b32 v174, v213, v209, s90
    v_perm_b32 v175, v221, v217, s90
    v_mov_b32 v29, v30
    v_mfma_f32_16x16x32_bf16 v[40:43], v[168:171], v[72:75], v[40:43]
    v_perm_b32 v176, v198, v194, s30
    v_perm_b32 v177, v206, v202, s30
    v_perm_b32 v178, v214, v210, s30
    v_perm_b32 v179, v222, v218, s30
    v_permlane16_swap_b32 v30, v29
    v_mfma_f32_16x16x32_bf16 v[44:47], v[172:175], v[72:75], v[44:47]
    v_perm_b32 v180, v198, v194, s90
    v_perm_b32 v181, v206, v202, s90
    v_perm_b32 v182, v214, v210, s90
    v_perm_b32 v183, v222, v218, s90
    v_add_f32 v30, v30, v29
    v_mfma_f32_16x16x32_bf16 v[48:51], v[176:179], v[72:75], v[48:51]
    v_perm_b32 v184, v199, v195, s30
    v_perm_b32 v185, v207, v203, s30
    v_perm_b32 v186, v215, v211, s30
    v_perm_b32 v187, v223, v219, s30
    v_mov_b32 v29, v30
    v_mfma_f32_16x16x32_bf16 v[52:55], v[180:183], v[72:75], v[52:55]
    v_perm_b32 v188, v199, v195, s90
    v_perm_b32 v189, v207, v203, s90
    v_perm_b32 v190, v215, v211, s90
    v_perm_b32 v191, v223, v219, s90
    v_permlane32_swap_b32 v30, v29
    v_mfma_f32_16x16x32_bf16 v[56:59], v[184:187], v[72:75], v[56:59]
    v_add_f32 v30, v30, v29
    v_mfma_f32_16x16x32_bf16 v[60:63], v[188:191], v[72:75], v[60:63]
    s_waitcnt vmcnt(0)
    v_perm_b32 v192, v228, v224, s30
    v_perm_b32 v193, v236, v232, s30
    v_perm_b32 v194, v244, v240, s30
    v_perm_b32 v195, v252, v248, s30
    v_perm_b32 v196, v228, v224, s90
    v_perm_b32 v197, v236, v232, s90
    v_perm_b32 v198, v244, v240, s90
    v_perm_b32 v199, v252, v248, s90
    v_mfma_f32_16x16x32_bf16 v[32:35], v[192:195], v[76:79], v[32:35]
    v_perm_b32 v200, v229, v225, s30
    v_perm_b32 v201, v237, v233, s30
    v_perm_b32 v202, v245, v241, s30
    v_perm_b32 v203, v253, v249, s30
    v_mfma_f32_16x16x32_bf16 v[36:39], v[196:199], v[76:79], v[36:39]
    v_perm_b32 v204, v229, v225, s90
    v_perm_b32 v205, v237, v233, s90
    v_perm_b32 v206, v245, v241, s90
    v_perm_b32 v207, v253, v249, s90
    v_mfma_f32_16x16x32_bf16 v[40:43], v[200:203], v[76:79], v[40:43]
    v_perm_b32 v208, v230, v226, s30
    v_perm_b32 v209, v238, v234, s30
    v_perm_b32 v210, v246, v242, s30
    v_perm_b32 v211, v254, v250, s30
    v_mfma_f32_16x16x32_bf16 v[44:47], v[204:207], v[76:79], v[44:47]
    v_perm_b32 v212, v230, v226, s90
    v_perm_b32 v213, v238, v234, s90
    v_perm_b32 v214, v246, v242, s90
    v_perm_b32 v215, v254, v250, s90
    v_mfma_f32_16x16x32_bf16 v[48:51], v[208:211], v[76:79], v[48:51]
    v_perm_b32 v216, v231, v227, s30
    v_perm_b32 v217, v239, v235, s30
    v_perm_b32 v218, v247, v243, s30
    v_perm_b32 v219, v255, v251, s30
    v_mfma_f32_16x16x32_bf16 v[52:55], v[212:215], v[76:79], v[52:55]
    v_perm_b32 v220, v231, v227, s90
    v_perm_b32 v221, v239, v235, s90
    v_perm_b32 v222, v247, v243, s90
    v_perm_b32 v223, v255, v251, s90
    v_mfma_f32_16x16x32_bf16 v[56:59], v[216:219], v[76:79], v[56:59]
    s_nop 0
    v_mfma_f32_16x16x32_bf16 v[60:63], v[220:223], v[76:79], v[60:63]
    s_cmp_eq_u32 s35, 0
    s_cbranch_scc1 L_to_51
    s_cmp_eq_u32 s35, 2
    s_cbranch_scc1 L_td_52
    s_branch L_tj_53
L_to_51:
    v_lshrrev_b32 v85, 3, v1
    v_and_b32 v84, 3, v85
    v_lshlrev_b32 v84, 3, v84
    v_lshrrev_b32 v85, 2, v85
    v_add_u32 v84, v84, v85
    s_lshl_b32 s29, s24, 7
    s_lshl_b32 s31, s20, 9
    s_add_u32 s29, s29, s31
    v_add_u32 v84, s29, v84
    v_lshlrev_b32 v84, 10, v84
    v_bfe_u32 v85, v1, 1, 2
    v_bfe_u32 v31, v1, 4, 1
    v_xor_b32 v85, v85, v31
    v_lshlrev_b32 v85, 5, v85
    v_and_b32 v31, 1, v1
    v_lshl_add_u32 v85, v31, 4, v85
    v_add_u32 v84, v84, v85
    s_lshl_b32 s29, s41, 7
    v_add_u32 v84, s29, v84
    v_xor_b32 v85, 64, v84
    s_lshl_b32 s100, s24, 14
    s_add_u32 s100, s100, 32768
    s_mov_b32 s92, s72
    s_mov_b32 s93, s73
    s_mov_b32 s94, 0x400000
    s_mov_b32 s95, 0x00020000
    s_add_u32 m0, s100, 0
    s_mov_b32 s96, 0
    buffer_load_dwordx4 v84, s[92:95], s96 offen nt lds
    s_add_u32 m0, s100, 1024
    s_mov_b32 s96, 2048
    buffer_load_dwordx4 v85, s[92:95], s96 offen nt lds
    s_add_u32 m0, s100, 2048
    s_mov_b32 s96, 4096
    buffer_load_dwordx4 v84, s[92:95], s96 offen nt lds
    s_add_u32 m0, s100, 3072
    s_mov_b32 s96, 6144
    buffer_load_dwordx4 v85, s[92:95], s96 offen nt lds
    s_add_u32 m0, s100, 4096
    s_mov_b32 s96, 32768
    buffer_load_dwordx4 v84, s[92:95], s96 offen nt lds
    s_add_u32 m0, s100, 5120
    s_mov_b32 s96, 34816
    buffer_load_dwordx4 v85, s[92:95], s96 offen nt lds
    s_add_u32 m0, s100, 6144
    s_mov_b32 s96, 36864
    buffer_load_dwordx4 v84, s[92:95], s96 offen nt lds
    s_add_u32 m0, s100, 7168
    s_mov_b32 s96, 38912
    buffer_load_dwordx4 v85, s[92:95], s96 offen nt lds
    s_branch L_tj_53
L_td_52:
    v_lshrrev_b32 v84, 3, v1
    s_mul_i32 s29, s20, 224
    s_lshl_b32 s31, s24, 6
    s_add_u32 s29, s29, s31
    v_add_u32 v84, s29, v84
    v_lshlrev_b32 v84, 10, v84
    v_bfe_u32 v85, v1, 1, 2
    v_bfe_u32 v31, v1, 4, 1
    v_xor_b32 v85, v85, v31
    v_lshlrev_b32 v85, 5, v85
    v_and_b32 v31, 1, v1
    v_lshl_add_u32 v85, v31, 4, v85
    v_add_u32 v84, v84, v85
    s_lshl_b32 s29, s41, 7
    v_add_u32 v84, s29, v84
    v_xor_b32 v85, 64, v84
    s_lshl_b32 s100, s24, 13
    s_add_u32 s100, s100, 32768
    s_mov_b32 s92, s80
    s_mov_b32 s93, s81
    s_mov_b32 s94, 0x1c0000
    s_mov_b32 s95, 0x00020000
    s_cmp_eq_u32 s24, 3
    s_cbranch_scc1 L_t3_55
    s_add_u32 m0, s100, 0
    s_mov_b32 s96, 0
    buffer_load_dwordx4 v84, s[92:95], s96 offen nt lds
    s_add_u32 m0, s100, 1024
    s_mov_b32 s96, 8192
    buffer_load_dwordx4 v85, s[92:95], s96 offen nt lds
    s_add_u32 m0, s100, 2048
    s_mov_b32 s96, 16384
    buffer_load_dwordx4 v84, s[92:95], s96 offen nt lds
    s_add_u32 m0, s100, 3072
    s_mov_b32 s96, 24576
    buffer_load_dwordx4 v85, s[92:95], s96 offen nt lds
    s_add_u32 m0, s100, 4096
    s_mov_b32 s96, 32768
    buffer_load_dwordx4 v84, s[92:95], s96 offen nt lds
    s_add_u32 m0, s100, 5120
    s_mov_b32 s96, 40960
    buffer_load_dwordx4 v85, s[92:95], s96 offen nt lds
    s_add_u32 m0, s100, 6144
    s_mov_b32 s96, 49152
    buffer_load_dwordx4 v84, s[92:95], s96 offen nt lds
    s_add_u32 m0, s100, 7168
    s_mov_b32 s96, 57344
    buffer_load_dwordx4 v85, s[92:95], s96 offen nt lds
    s_branch L_tj_53
L_t3_55:
    s_add_u32 m0, s100, 0
    s_mov_b32 s96, 0
    buffer_load_dwordx4 v84, s[92:95], s96 offen nt lds
    s_add_u32 m0, s100, 1024
    s_mov_b32 s96, 8192
    buffer_load_dwordx4 v85, s[92:95], s96 offen nt lds
    s_add_u32 m0, s100, 2048
    s_mov_b32 s96, 16384
    buffer_load_dwordx4 v84, s[92:95], s96 offen nt lds
    s_add_u32 m0, s100, 3072
    s_mov_b32 s96, 24576
    buffer_load_dwordx4 v85, s[92:95], s96 offen nt lds
L_tj_53:
L_sjoin_22:
    s_lshl_b32 s29, s24, 5
    v_mov_b32 v0, s29
    s_lshr_b32 s29, s21, 4
    s_lshl_b32 s29, s29, 9
    s_lshl_b32 s30, s24, 7
    s_add_u32 s29, s29, s30
    s_and_b32 s30, s21, 15
    s_lshl_b32 s30, s30, 3
    s_add_u32 s29, s29, s30
    v_mov_b32 v20, s29
    v_and_b32 v21, 3, v2
    v_lshlrev_b32 v21, 8, v21
    v_lshl_add_u32 v21, v3, 4, v21
L_tail:
B_tail:
    v_mov_b32 v29, v30
    s_mov_b64 exec, s[52:53]
    ds_write_b128 v18, v[32:35] offset:12288
    ds_write_b128 v18, v[36:39] offset:12560
    ds_write_b128 v18, v[40:43] offset:12832
    ds_write_b128 v18, v[44:47] offset:13104
    ds_write_b128 v18, v[48:51] offset:13376
    ds_write_b128 v18, v[52:55] offset:13648
    ds_write_b128 v18, v[56:59] offset:13920
    ds_write_b128 v18, v[60:63] offset:14192
    s_mov_b64 exec, s[60:61]
    ds_write_b64 v16, v[28:29] offset:20992
    s_mov_b64 exec, -1
    s_waitcnt lgkmcnt(0)
    s_barrier
    ds_read_b128 v[40:43], v0 offset:20992
    ds_read_b128 v[44:47], v0 offset:21008
    ds_read_b64 v[32:33], v19 offset:12288
    ds_read_b64 v[34:35], v19 offset:14464
    ds_read_b64 v[36:37], v19 offset:16640
    ds_read_b64 v[38:39], v19 offset:18816
    s_waitcnt lgkmcnt(4)
    v_max3_f32 v28, v40, v42, v44
    v_max_f32 v28, v28, v46
    v_sub_f32 v40, v40, v28
    v_sub_f32 v42, v42, v28
    v_sub_f32 v44, v44, v28
    v_sub_f32 v46, v46, v28
    v_exp_f32 v40, v40
    v_exp_f32 v42, v42
    v_exp_f32 v44, v44
    v_exp_f32 v46, v46
    v_mul_f32 v29, v40, v41
    v_mul_f32 v30, v44, v45
    v_fma_f32 v29, v42, v43, v29
    v_fma_f32 v30, v46, v47, v30
    s_waitcnt lgkmcnt(0)
    v_mul_f32 v48, v40, v32
    v_mul_f32 v49, v40, v33
    v_add_f32 v29, v29, v30
    v_mul_f32 v50, v44, v36
    v_mul_f32 v51, v44, v37
    v_rcp_f32 v30, v29
    v_fma_f32 v48, v42, v34, v48
    v_fma_f32 v49, v42, v35, v49
    v_fma_f32 v50, v46, v38, v50
    v_fma_f32 v51, v46, v39, v51
    v_add_f32 v48, v48, v50
    v_add_f32 v49, v49, v51
    v_mul_f32 v48, v30, v48
    v_mul_f32 v49, v30, v49
    v_cvt_pk_bf16_f32 v30, v48, v49
    s_cmp_eq_u32 s26, 1
    s_cbranch_scc0 L_nl_56
    buffer_store_dword v30, v8, s[4:7], s33 offen
L_nb_57:
    s_mov_b64 exec, 1
    s_cmp_eq_u32 s26, 1
    s_cbranch_scc0 L_nl_58
    buffer_store_dwordx2 v[28:29], v20, s[4:7], s97 offen
L_nb_59:
    s_mov_b64 exec, -1
    s_cmp_lg_u32 s25, 0
    s_cbranch_scc1 L_nogt_60
    s_cmp_lg_u32 s35, 0
    s_cbranch_scc1 L_roleskip_61
    s_add_u32 m0, s100, 8192
    s_mov_b32 s96, 65536
    buffer_load_dwordx4 v84, s[92:95], s96 offen nt lds
    s_add_u32 m0, s100, 9216
    s_mov_b32 s96, 67584
    buffer_load_dwordx4 v85, s[92:95], s96 offen nt lds
    s_add_u32 m0, s100, 10240
    s_mov_b32 s96, 69632
    buffer_load_dwordx4 v84, s[92:95], s96 offen nt lds
    s_add_u32 m0, s100, 11264
    s_mov_b32 s96, 71680
    buffer_load_dwordx4 v85, s[92:95], s96 offen nt lds
    s_add_u32 m0, s100, 12288
    s_mov_b32 s96, 98304
    buffer_load_dwordx4 v84, s[92:95], s96 offen nt lds
    s_add_u32 m0, s100, 13312
    s_mov_b32 s96, 100352
    buffer_load_dwordx4 v85, s[92:95], s96 offen nt lds
    s_add_u32 m0, s100, 14336
    s_mov_b32 s96, 102400
    buffer_load_dwordx4 v84, s[92:95], s96 offen nt lds
    s_add_u32 m0, s100, 15360
    s_mov_b32 s96, 104448
    buffer_load_dwordx4 v85, s[92:95], s96 offen nt lds
L_roleskip_61:
    s_cmp_lg_u32 s35, 1
    s_cbranch_scc1 L_gtj_62
    v_lshrrev_b32 v84, 2, v1
    s_lshl_b32 s29, s24, 7
    v_add_u32 v84, s29, v84
    v_mul_u32_u24 v84, 3584, v84
    v_bfe_u32 v85, v1, 1, 1
    v_bfe_u32 v31, v1, 5, 1
    v_xor_b32 v85, v85, v31
    v_lshl_add_u32 v84, v85, 5, v84
    v_and_b32 v31, 1, v1
    v_lshl_add_u32 v84, v31, 4, v84
    s_mul_i32 s29, s20, 448
    s_lshl_b32 s31, s41, 6
    s_add_u32 s29, s29, s31
    v_add_u32 v84, s29, v84
    s_lshl_b32 s100, s24, 13
    s_mov_b32 s92, s76
    s_mov_b32 s93, s77
    s_mov_b32 s94, 0x1c0000
    s_mov_b32 s95, 0x00020000
    s_mov_b32 s16, s78
    s_mov_b32 s17, s79
    s_mov_b32 s18, 0x1c0000
    s_mov_b32 s19, 0x00020000
    s_cmp_lg_u32 s24, 0
    s_cbranch_scc1 L_gw_64
    s_add_u32 m0, s100, 32768
    s_mov_b32 s96, 0
    buffer_load_dwordx4 v84, s[92:95], s96 offen nt lds
    s_add_u32 m0, s100, 65536
    s_mov_b32 s96, 0
    buffer_load_dwordx4 v84, s[16:19], s96 offen nt lds
    s_add_u32 m0, s100, 33792
    s_mov_b32 s96, 57344
    buffer_load_dwordx4 v84, s[92:95], s96 offen nt lds
    s_add_u32 m0, s100, 66560
    s_mov_b32 s96, 57344
    buffer_load_dwordx4 v84, s[16:19], s96 offen nt lds
    s_add_u32 m0, s100, 34816
    s_mov_b32 s96, 114688
    buffer_load_dwordx4 v84, s[92:95], s96 offen nt lds
    s_add_u32 m0, s100, 67584
    s_mov_b32 s96, 114688
    buffer_load_dwordx4 v84, s[16:19], s96 offen nt lds
    s_add_u32 m0, s100, 35840
    s_mov_b32 s96, 172032
    buffer_load_dwordx4 v84, s[92:95], s96 offen nt lds
    s_add_u32 m0, s100, 68608
    s_mov_b32 s96, 172032
    buffer_load_dwordx4 v84, s[16:19], s96 offen nt lds
    s_add_u32 m0, s100, 36864
    s_mov_b32 s96, 229376
    buffer_load_dwordx4 v84, s[92:95], s96 offen nt lds
    s_add_u32 m0, s100, 69632
    s_mov_b32 s96, 229376
    buffer_load_dwordx4 v84, s[16:19], s96 offen nt lds
    s_add_u32 m0, s100, 37888
    s_mov_b32 s96, 286720
    buffer_load_dwordx4 v84, s[92:95], s96 offen nt lds
    s_add_u32 m0, s100, 70656
    s_mov_b32 s96, 286720
    buffer_load_dwordx4 v84, s[16:19], s96 offen nt lds
    s_add_u32 m0, s100, 38912
    s_mov_b32 s96, 344064
    buffer_load_dwordx4 v84, s[92:95], s96 offen nt lds
    s_add_u32 m0, s100, 71680
    s_mov_b32 s96, 344064
    buffer_load_dwordx4 v84, s[16:19], s96 offen nt lds
    s_add_u32 m0, s100, 39936
    s_mov_b32 s96, 401408
    buffer_load_dwordx4 v84, s[92:95], s96 offen nt lds
    s_add_u32 m0, s100, 72704
    s_mov_b32 s96, 401408
    buffer_load_dwordx4 v84, s[16:19], s96 offen nt lds
    s_branch L_gj_65
L_gw_64:
    s_sleep 2
    s_add_u32 m0, s100, 32768
    s_mov_b32 s96, 0
    buffer_load_dwordx4 v84, s[92:95], s96 offen nt lds
    s_add_u32 m0, s100, 65536
    s_mov_b32 s96, 0
    buffer_load_dwordx4 v84, s[16:19], s96 offen nt lds
    s_add_u32 m0, s100, 33792
    s_mov_b32 s96, 57344
    buffer_load_dwordx4 v84, s[92:95], s96 offen nt lds
    s_add_u32 m0, s100, 66560
    s_mov_b32 s96, 57344
    buffer_load_dwordx4 v84, s[16:19], s96 offen nt lds
    s_add_u32 m0, s100, 34816
    s_mov_b32 s96, 114688
    buffer_load_dwordx4 v84, s[92:95], s96 offen nt lds
    s_add_u32 m0, s100, 67584
    s_mov_b32 s96, 114688
    buffer_load_dwordx4 v84, s[16:19], s96 offen nt lds
    s_add_u32 m0, s100, 35840
    s_mov_b32 s96, 172032
    s_waitcnt vmcnt(5)
    buffer_load_dwordx4 v84, s[92:95], s96 offen nt lds
    s_add_u32 m0, s100, 68608
    s_mov_b32 s96, 172032
    s_waitcnt vmcnt(5)
    buffer_load_dwordx4 v84, s[16:19], s96 offen nt lds
    s_add_u32 m0, s100, 36864
    s_mov_b32 s96, 229376
    s_waitcnt vmcnt(5)
    buffer_load_dwordx4 v84, s[92:95], s96 offen nt lds
    s_add_u32 m0, s100, 69632
    s_mov_b32 s96, 229376
    s_waitcnt vmcnt(5)
    buffer_load_dwordx4 v84, s[16:19], s96 offen nt lds
    s_add_u32 m0, s100, 37888
    s_mov_b32 s96, 286720
    s_waitcnt vmcnt(5)
    buffer_load_dwordx4 v84, s[92:95], s96 offen nt lds
    s_add_u32 m0, s100, 70656
    s_mov_b32 s96, 286720
    s_waitcnt vmcnt(5)
    buffer_load_dwordx4 v84, s[16:19], s96 offen nt lds
    s_add_u32 m0, s100, 38912
    s_mov_b32 s96, 344064
    s_waitcnt vmcnt(5)
    buffer_load_dwordx4 v84, s[92:95], s96 offen nt lds
    s_add_u32 m0, s100, 71680
    s_mov_b32 s96, 344064
    s_waitcnt vmcnt(5)
    buffer_load_dwordx4 v84, s[16:19], s96 offen nt lds
    s_add_u32 m0, s100, 39936
    s_mov_b32 s96, 401408
    s_waitcnt vmcnt(5)
    buffer_load_dwordx4 v84, s[92:95], s96 offen nt lds
    s_add_u32 m0, s100, 72704
    s_mov_b32 s96, 401408
    s_waitcnt vmcnt(5)
    buffer_load_dwordx4 v84, s[16:19], s96 offen nt lds
L_gj_65:
    s_waitcnt vmcnt(0)
    v_lshrrev_b32 v28, 2, v2
    v_lshl_add_u32 v29, v3, 3, v28
    s_lshl_b32 s30, s24, 7
    v_add_u32 v29, s30, v29
    v_lshlrev_b32 v29, 6, v29
    v_and_b32 v30, 1, v3
    v_lshl_add_u32 v29, v30, 5, v29
    v_and_b32 v28, 3, v2
    v_lshl_add_u32 v29, v28, 3, v29
    v_add_u32 v29, 32768, v29
    v_xor_b32 v28, 32, v29
    ds_read_b64_tr_b16 a[128:129], v29 offset:0
    ds_read_b64_tr_b16 a[130:131], v29 offset:256
    ds_read_b64_tr_b16 a[144:145], v29 offset:2048
    ds_read_b64_tr_b16 a[146:147], v29 offset:2304
    ds_read_b64_tr_b16 a[160:161], v29 offset:4096
    ds_read_b64_tr_b16 a[162:163], v29 offset:4352
    ds_read_b64_tr_b16 a[176:177], v29 offset:6144
    ds_read_b64_tr_b16 a[178:179], v29 offset:6400
    ds_read_b64_tr_b16 a[132:133], v28 offset:0
    ds_read_b64_tr_b16 a[134:135], v28 offset:256
    ds_read_b64_tr_b16 a[148:149], v28 offset:2048
    ds_read_b64_tr_b16 a[150:151], v28 offset:2304
    ds_read_b64_tr_b16 a[164:165], v28 offset:4096
    ds_read_b64_tr_b16 a[166:167], v28 offset:4352
    ds_read_b64_tr_b16 a[180:181], v28 offset:6144
    ds_read_b64_tr_b16 a[182:183], v28 offset:6400
    ds_read_b64_tr_b16 a[136:137], v29 offset:32768
    ds_read_b64_tr_b16 a[138:139], v29 offset:33024
    ds_read_b64_tr_b16 a[152:153], v29 offset:34816
    ds_read_b64_tr_b16 a[154:155], v29 offset:35072
    ds_read_b64_tr_b16 a[168:169], v29 offset:36864
    ds_read_b64_tr_b16 a[170:171], v29 offset:37120
    ds_read_b64_tr_b16 a[184:185], v29 offset:38912
    ds_read_b64_tr_b16 a[186:187], v29 offset:39168
    ds_read_b64_tr_b16 a[140:141], v28 offset:32768
    ds_read_b64_tr_b16 a[142:143], v28 offset:33024
    ds_read_b64_tr_b16 a[156:157], v28 offset:34816
    ds_read_b64_tr_b16 a[158:159], v28 offset:35072
    ds_read_b64_tr_b16 a[172:173], v28 offset:36864
    ds_read_b64_tr_b16 a[174:175], v28 offset:37120
    ds_read_b64_tr_b16 a[188:189], v28 offset:38912
    ds_read_b64_tr_b16 a[190:191], v28 offset:39168
L_gtj_62:
L_nogt_60:
    s_cmp_lg_u32 s35, 0
    s_cbranch_scc1 L_roleskip_66
B_o:
    s_cmp_lg_u32 s25, 0
    s_cbranch_scc1 L_nowo_67
    s_waitcnt vmcnt(0)
    v_lshrrev_b32 v28, 2, v2
    v_lshl_add_u32 v29, v3, 3, v28
    s_mul_i32 s30, s24, 128
    v_add_u32 v29, s30, v29
    v_lshlrev_b32 v29, 7, v29
    v_lshrrev_b32 v28, 1, v28
    v_and_b32 v30, 1, v3
    v_lshl_add_u32 v28, v30, 1, v28
    v_lshl_add_u32 v29, v28, 5, v29
    v_and_b32 v28, 3, v2
    v_lshl_add_u32 v29, v28, 3, v29
    v_add_u32 v29, 32768, v29
    ds_read_b64_tr_b16 a[128:129], v29 offset:0
    ds_read_b64_tr_b16 a[130:131], v29 offset:512
    ds_read_b64_tr_b16 a[144:145], v29 offset:4096
    ds_read_b64_tr_b16 a[146:147], v29 offset:4608
    ds_read_b64_tr_b16 a[160:161], v29 offset:8192
    ds_read_b64_tr_b16 a[162:163], v29 offset:8704
    ds_read_b64_tr_b16 a[176:177], v29 offset:12288
    ds_read_b64_tr_b16 a[178:179], v29 offset:12800
    v_xor_b32 v28, 32, v29
    ds_read_b64_tr_b16 a[132:133], v28 offset:0
    ds_read_b64_tr_b16 a[134:135], v28 offset:512
    ds_read_b64_tr_b16 a[148:149], v28 offset:4096
    ds_read_b64_tr_b16 a[150:151], v28 offset:4608
    ds_read_b64_tr_b16 a[164:165], v28 offset:8192
    ds_read_b64_tr_b16 a[166:167], v28 offset:8704
    ds_read_b64_tr_b16 a[180:181], v28 offset:12288
    ds_read_b64_tr_b16 a[182:183], v28 offset:12800
    v_xor_b32 v28, 64, v29
    ds_read_b64_tr_b16 a[136:137], v28 offset:0
    ds_read_b64_tr_b16 a[138:139], v28 offset:512
    ds_read_b64_tr_b16 a[152:153], v28 offset:4096
    ds_read_b64_tr_b16 a[154:155], v28 offset:4608
    ds_read_b64_tr_b16 a[168:169], v28 offset:8192
    ds_read_b64_tr_b16 a[170:171], v28 offset:8704
    ds_read_b64_tr_b16 a[184:185], v28 offset:12288
    ds_read_b64_tr_b16 a[186:187], v28 offset:12800
    v_xor_b32 v28, 96, v29
    ds_read_b64_tr_b16 a[140:141], v28 offset:0
    ds_read_b64_tr_b16 a[142:143], v28 offset:512
    ds_read_b64_tr_b16 a[156:157], v28 offset:4096
    ds_read_b64_tr_b16 a[158:159], v28 offset:4608
    ds_read_b64_tr_b16 a[172:173], v28 offset:8192
    ds_read_b64_tr_b16 a[174:175], v28 offset:8704
    ds_read_b64_tr_b16 a[188:189], v28 offset:12288
    ds_read_b64_tr_b16 a[190:191], v28 offset:12800
L_nowo_67:
    s_mov_b32 s28, s27
    v_mov_b32 v64, 0
    v_mov_b32 v65, 1.0
L_po_68:
    s_mov_b64 exec, s[52:53]
    buffer_load_dwordx2 v[64:65], v5, s[4:7], s97 offen sc1
    s_mov_b64 exec, -1
    buffer_load_dwordx4 v[48:51], v4, s[4:7], s33 offen offset:0 sc1
    buffer_load_dwordx4 v[52:55], v4, s[4:7], s33 offen offset:1024 sc1
    buffer_load_dwordx4 v[56:59], v4, s[4:7], s33 offen offset:2048 sc1
    buffer_load_dwordx4 v[60:63], v4, s[4:7], s33 offen offset:3072 sc1
    s_waitcnt vmcnt(0)
    v_max3_u32 v28, v48, v51, v54
    v_max3_u32 v29, v49, v52, v55
    v_max3_u32 v30, v50, v53, v56
    v_max3_u32 v28, v28, v57, v60
    v_max3_u32 v29, v29, v58, v61
    v_max3_u32 v30, v30, v59, v62
    v_max_u32 v28, v28, v63
    v_max_u32 v29, v29, v64
    v_max_u32 v30, v30, v65
    v_max3_u32 v28, v28, v29, v30
    v_cmp_eq_u32 vcc, -1, v28
    s_cbranch_vccz L_pod_69
    s_sub_u32 s28, s28, 1
    s_cbranch_scc0 L_po_68
    s_mov_b32 s27, 0
L_pod_69:
    s_waitcnt lgkmcnt(0)
    v_mfma_f32_16x16x32_bf16 v[32:35], v[48:51], a[128:131], 0
    v_max_f32_dpp v66, v64, v64 quad_perm:[1,0,3,2] row_mask:0xf bank_mask:0xf
    s_nop 0
    v_mfma_f32_16x16x32_bf16 v[36:39], v[48:51], a[132:135], 0
    v_max_f32_dpp v66, v66, v66 quad_perm:[2,3,0,1] row_mask:0xf bank_mask:0xf
    s_nop 0
    v_mfma_f32_16x16x32_bf16 v[40:43], v[48:51], a[136:139], 0
    v_sub_f32 v66, v64, v66
    s_nop 0
    v_mfma_f32_16x16x32_bf16 v[44:47], v[48:51], a[140:143], 0
    v_exp_f32 v66, v66
    s_nop 0
    v_mfma_f32_16x16x32_bf16 v[32:35], v[52:55], a[144:147], v[32:35]
    v_mul_f32 v66, v66, v65
    s_nop 0
    v_mfma_f32_16x16x32_bf16 v[36:39], v[52:55], a[148:151], v[36:39]
    v_add_f32_dpp v67, v66, v66 quad_perm:[1,0,3,2] row_mask:0xf bank_mask:0xf
    s_nop 0
    v_mfma_f32_16x16x32_bf16 v[40:43], v[52:55], a[152:155], v[40:43]
    v_add_f32_dpp v67, v67, v67 quad_perm:[2,3,0,1] row_mask:0xf bank_mask:0xf
    s_nop 0
    v_mfma_f32_16x16x32_bf16 v[44:47], v[52:55], a[156:159], v[44:47]
    v_rcp_f32 v67, v67
    s_nop 0
    v_mfma_f32_16x16x32_bf16 v[32:35], v[56:59], a[160:163], v[32:35]
    v_mul_f32 v66, v66, v67
    s_nop 0
    v_mfma_f32_16x16x32_bf16 v[36:39], v[56:59], a[164:167], v[36:39]
    v_mfma_f32_16x16x32_bf16 v[40:43], v[56:59], a[168:171], v[40:43]
    v_mfma_f32_16x16x32_bf16 v[44:47], v[56:59], a[172:175], v[44:47]
    v_mfma_f32_16x16x32_bf16 v[32:35], v[60:63], a[176:179], v[32:35]
    v_mfma_f32_16x16x32_bf16 v[36:39], v[60:63], a[180:183], v[36:39]
    v_mfma_f32_16x16x32_bf16 v[40:43], v[60:63], a[184:187], v[40:43]
    v_mfma_f32_16x16x32_bf16 v[44:47], v[60:63], a[188:191], v[44:47]
    s_nop 4
    v_mul_f32_dpp v80, v66, v32 row_newbcast:0 row_mask:0xf bank_mask:0xf
    v_mul_f32_dpp v81, v66, v36 row_newbcast:0 row_mask:0xf bank_mask:0xf
    v_mul_f32_dpp v82, v66, v40 row_newbcast:0 row_mask:0xf bank_mask:0xf
    v_mul_f32_dpp v83, v66, v44 row_newbcast:0 row_mask:0xf bank_mask:0xf
    v_fmac_f32_dpp v80, v66, v33 row_newbcast:1 row_mask:0xf bank_mask:0xf
    v_fmac_f32_dpp v81, v66, v37 row_newbcast:1 row_mask:0xf bank_mask:0xf
    v_fmac_f32_dpp v82, v66, v41 row_newbcast:1 row_mask:0xf bank_mask:0xf
    v_fmac_f32_dpp v83, v66, v45 row_newbcast:1 row_mask:0xf bank_mask:0xf
    v_fmac_f32_dpp v80, v66, v34 row_newbcast:2 row_mask:0xf bank_mask:0xf
    v_fmac_f32_dpp v81, v66, v38 row_newbcast:2 row_mask:0xf bank_mask:0xf
    v_fmac_f32_dpp v82, v66, v42 row_newbcast:2 row_mask:0xf bank_mask:0xf
    v_fmac_f32_dpp v83, v66, v46 row_newbcast:2 row_mask:0xf bank_mask:0xf
    v_fmac_f32_dpp v80, v66, v35 row_newbcast:3 row_mask:0xf bank_mask:0xf
    v_fmac_f32_dpp v81, v66, v39 row_newbcast:3 row_mask:0xf bank_mask:0xf
    v_fmac_f32_dpp v82, v66, v43 row_newbcast:3 row_mask:0xf bank_mask:0xf
    v_fmac_f32_dpp v83, v66, v47 row_newbcast:3 row_mask:0xf bank_mask:0xf
    ds_write_b32 v14, v80 offset:0
    ds_write_b32 v14, v81 offset:64
    ds_write_b32 v14, v82 offset:128
    ds_write_b32 v14, v83 offset:192
    s_waitcnt lgkmcnt(0)
    s_barrier
    s_mov_b64 exec, s[58:59]
    ds_read_b128 v[32:35], v9 offset:0
    ds_read_b128 v[36:39], v9 offset:2560
    ds_read_b128 v[40:43], v9 offset:5120
    ds_read_b128 v[44:47], v9 offset:7680
    s_waitcnt lgkmcnt(0)
    v_pk_add_f32 v[32:33], v[32:33], v[36:37]
    v_pk_add_f32 v[34:35], v[34:35], v[38:39]
    v_pk_add_f32 v[40:41], v[40:41], v[44:45]
    v_pk_add_f32 v[42:43], v[42:43], v[46:47]
    v_pk_add_f32 v[32:33], v[32:33], v[40:41]
    v_pk_add_f32 v[34:35], v[34:35], v[42:43]
    buffer_store_dwordx4 v[32:35], v11, s[4:7], s34 offen sc1
    s_mov_b64 exec, -1
    s_cmp_lg_u32 s24, 0
    s_cbranch_scc1 L_w0skip_70
    s_lshl_b32 s31, s25, 14
    s_lshl_b32 s30, s20, 10
    s_add_u32 s31, s31, s30
    s_lshl_b32 s30, s41, 7
    s_add_u32 s31, s31, s30
    s_add_u32 s31, s31, 1511424
    v_mov_b32 v28, 0
    s_mov_b64 exec, 1
    s_cmp_eq_u32 s26, 1
    s_cbranch_scc0 L_nl_71
    buffer_store_dword v28, v28, s[4:7], s31 offen
L_nb_72:
    s_mov_b64 exec, -1
L_w0skip_70:
L_roleskip_66:
    s_cmp_lg_u32 s24, 0
    s_cbranch_scc1 L_w0skip_73
B_y:
    s_cmp_lg_u32 s35, 0
    s_cbranch_scc1 L_sl_75
    s_sleep 10
    s_branch L_slj_74
L_sl_75:
    s_lshr_b32 s29, s21, 2
    s_lshl_b32 s31, s25, 14
    s_lshl_b32 s30, s20, 10
    s_add_u32 s31, s31, s30
    s_lshl_b32 s30, s29, 7
    s_add_u32 s31, s31, s30
    s_add_u32 s31, s31, 1511424
    v_mov_b32 v33, 0
    s_mov_b32 s28, s27
    s_mov_b64 exec, 1
L_cp_76:
    buffer_load_dword v32, v33, s[4:7], s31 offen sc1
    s_waitcnt vmcnt(0)
    v_cmp_eq_u32 vcc, -1, v32
    s_cbranch_vccz L_cd_77
    s_sleep 1
    s_sub_u32 s28, s28, 1
    s_cbranch_scc0 L_cp_76
L_cd_77:
    s_mov_b64 exec, -1
    s_sleep 3
L_slj_74:
    s_mov_b32 s28, s27
L_pr_78:
    buffer_load_dwordx4 v[32:35], v6, s[4:7], s36 offen offset:0 sc1
    buffer_load_dwordx4 v[36:39], v6, s[4:7], s36 offen offset:1024 sc1
    buffer_load_dwordx4 v[40:43], v6, s[4:7], s36 offen offset:2048 sc1
    buffer_load_dwordx4 v[44:47], v6, s[4:7], s36 offen offset:3072 sc1
    s_waitcnt vmcnt(0)
    v_max3_u32 v28, v32, v35, v38
    v_max3_u32 v29, v33, v36, v39
    v_max3_u32 v30, v34, v37, v40
    v_max3_u32 v28, v28, v41, v44
    v_max3_u32 v29, v29, v42, v45
    v_max3_u32 v30, v30, v43, v46
    v_max_u32 v28, v28, v47
    v_max3_u32 v28, v28, v29, v30
    v_cmp_eq_u32 vcc, -1, v28
    s_cbranch_vccz L_prd_79
    s_sub_u32 s28, s28, 1
    s_cbranch_scc0 L_pr_78
    s_mov_b32 s27, 0
L_prd_79:
    v_pk_add_f32 v[32:33], v[32:33], v[36:37]
    v_pk_add_f32 v[34:35], v[34:35], v[38:39]
    v_pk_add_f32 v[40:41], v[40:41], v[44:45]
    v_pk_add_f32 v[42:43], v[42:43], v[46:47]
    v_pk_add_f32 v[32:33], v[32:33], v[40:41]
    v_pk_add_f32 v[34:35], v[34:35], v[42:43]
    v_mov_b32 v36, v32
    v_mov_b32 v37, v33
    v_mov_b32 v38, v34
    v_mov_b32 v39, v35
    v_permlane32_swap_b32 v32, v36
    v_permlane32_swap_b32 v33, v37
    v_permlane32_swap_b32 v34, v38
    v_permlane32_swap_b32 v35, v39
    v_pk_add_f32 v[32:33], v[32:33], v[36:37]
    v_pk_add_f32 v[34:35], v[34:35], v[38:39]
    v_pk_add_f32 v[24:25], v[24:25], v[32:33]
    v_pk_add_f32 v[26:27], v[26:27], v[34:35]
    v_cvt_pk_bf16_f32 v28, v24, v25
    v_cvt_pk_bf16_f32 v29, v26, v27
    s_mov_b64 exec, s[54:55]
    s_cmp_eq_u32 s26, 1
    s_cbranch_scc0 L_nl_80
    buffer_store_dwordx2 v[28:29], v7, s[4:7], s37 offen
L_nb_81:
    s_mov_b64 exec, -1
    v_lshlrev_b32 v24, 16, v28
    v_and_b32 v25, 0xffff0000, v28
    v_lshlrev_b32 v26, 16, v29
    v_and_b32 v27, 0xffff0000, v29
L_w0skip_73:
    s_cmp_lg_u32 s35, 1
    s_cbranch_scc1 L_roleskip_82
B_g:
    v_mov_b32 v32, 0x3f803f80
    v_mov_b32 v33, 0x3f803f80
    v_mov_b32 v34, 0x3f803f80
    v_mov_b32 v35, 0x3f803f80
    v_mov_b32 v36, 0x3f803f80
    v_mov_b32 v37, 0x3f803f80
    v_mov_b32 v38, 0x3f803f80
    v_mov_b32 v39, 0x3f803f80
    v_mov_b32 v40, 0x3f803f80
    v_mov_b32 v41, 0x3f803f80
    v_mov_b32 v42, 0x3f803f80
    v_mov_b32 v43, 0x3f803f80
    v_mov_b32 v44, 0x3f803f80
    v_mov_b32 v45, 0x3f803f80
    v_mov_b32 v46, 0x3f803f80
    v_mov_b32 v47, 0x3f803f80
    s_mov_b32 s28, s27
    s_mov_b64 exec, s[50:51]
L_pa_83:
    buffer_load_dwordx4 v[32:35], v4, s[4:7], s37 offen offset:0 sc1
    buffer_load_dwordx4 v[36:39], v4, s[4:7], s37 offen offset:512 sc1
    buffer_load_dwordx4 v[40:43], v4, s[4:7], s37 offen offset:1024 sc1
    buffer_load_dwordx4 v[44:47], v4, s[4:7], s37 offen offset:1536 sc1
    s_waitcnt vmcnt(0)
    v_max3_u32 v28, v32, v35, v38
    v_max3_u32 v29, v33, v36, v39
    v_max3_u32 v30, v34, v37, v40
    v_max3_u32 v28, v28, v41, v44
    v_max3_u32 v29, v29, v42, v45
    v_max3_u32 v30, v30, v43, v46
    v_max_u32 v28, v28, v47
    v_max3_u32 v28, v28, v29, v30
    v_cmp_eq_u32 vcc, -1, v28
    s_cbranch_vccz L_pad_84
    s_sub_u32 s28, s28, 1
    s_cbranch_scc0 L_pa_83
    s_mov_b32 s27, 0
L_pad_84:
    s_mov_b64 exec, -1
    s_waitcnt lgkmcnt(0)
    s_cmp_lg_u32 s25, 0
    s_cbranch_scc1 L_gcs_85
    v_mfma_f32_16x16x32_bf16 v[80:83], v[32:35], v[32:35], 0
    v_mfma_f32_16x16x32_bf16 v[48:51], v[32:35], a[128:131], 0
    v_mfma_f32_16x16x32_bf16 v[52:55], v[32:35], a[132:135], 0
    v_mfma_f32_16x16x32_bf16 v[56:59], v[32:35], a[136:139], 0
    v_mfma_f32_16x16x32_bf16 v[60:63], v[32:35], a[140:143], 0
    v_mfma_f32_16x16x32_bf16 v[80:83], v[36:39], v[36:39], v[80:83]
    v_mfma_f32_16x16x32_bf16 v[48:51], v[36:39], a[144:147], v[48:51]
    v_mfma_f32_16x16x32_bf16 v[52:55], v[36:39], a[148:151], v[52:55]
    v_mfma_f32_16x16x32_bf16 v[56:59], v[36:39], a[152:155], v[56:59]
    v_mfma_f32_16x16x32_bf16 v[60:63], v[36:39], a[156:159], v[60:63]
    v_mfma_f32_16x16x32_bf16 v[80:83], v[40:43], v[40:43], v[80:83]
    v_mfma_f32_16x16x32_bf16 v[48:51], v[40:43], a[160:163], v[48:51]
    v_mfma_f32_16x16x32_bf16 v[52:55], v[40:43], a[164:167], v[52:55]
    v_mfma_f32_16x16x32_bf16 v[56:59], v[40:43], a[168:171], v[56:59]
    v_mfma_f32_16x16x32_bf16 v[60:63], v[40:43], a[172:175], v[60:63]
    v_mfma_f32_16x16x32_bf16 v[80:83], v[44:47], v[44:47], v[80:83]
    v_mfma_f32_16x16x32_bf16 v[48:51], v[44:47], a[176:179], v[48:51]
    v_mfma_f32_16x16x32_bf16 v[52:55], v[44:47], a[180:183], v[52:55]
    v_mfma_f32_16x16x32_bf16 v[56:59], v[44:47], a[184:187], v[56:59]
    v_mfma_f32_16x16x32_bf16 v[60:63], v[44:47], a[188:191], v[60:63]
    s_nop 3
    v_cndmask_b32 v28, v80, v81, s[42:43]
    v_cndmask_b32 v28, v28, v82, s[44:45]
    v_cndmask_b32 v28, v28, v83, s[46:47]
    s_mov_b64 exec, s[48:49]
    ds_write_b32 v15, v28 offset:10240
    s_mov_b64 exec, s[62:63]
    ds_write_b32 v13, v48 offset:0
    ds_write_b32 v13, v52 offset:64
    ds_write_b32 v13, v56 offset:128
    ds_write_b32 v13, v60 offset:192
    s_mov_b64 exec, s[54:55]
    ds_write_b32 v13, v49 offset:272
    ds_write_b32 v13, v53 offset:336
    ds_write_b32 v13, v57 offset:400
    ds_write_b32 v13, v61 offset:464
    ds_write_b32 v13, v50 offset:544
    ds_write_b32 v13, v54 offset:608
    ds_write_b32 v13, v58 offset:672
    ds_write_b32 v13, v62 offset:736
    ds_write_b32 v13, v51 offset:816
    ds_write_b32 v13, v55 offset:880
    ds_write_b32 v13, v59 offset:944
    ds_write_b32 v13, v63 offset:1008
    s_mov_b64 exec, -1
    s_waitcnt lgkmcnt(0)
    s_barrier
    s_branch L_gcj_86
L_gcs_85:
    v_mfma_f32_16x16x32_bf16 v[80:83], v[32:35], v[32:35], 0
    v_mfma_f32_16x16x32_bf16 v[48:51], v[32:35], a[128:131], 0
    v_mfma_f32_16x16x32_bf16 v[52:55], v[32:35], a[132:135], 0
    v_mfma_f32_16x16x32_bf16 v[56:59], v[32:35], a[136:139], 0
    v_mfma_f32_16x16x32_bf16 v[60:63], v[32:35], a[140:143], 0
    v_mfma_f32_16x16x32_bf16 v[80:83], v[36:39], v[36:39], v[80:83]
    v_mfma_f32_16x16x32_bf16 v[48:51], v[36:39], a[144:147], v[48:51]
    v_mfma_f32_16x16x32_bf16 v[52:55], v[36:39], a[148:151], v[52:55]
    v_mfma_f32_16x16x32_bf16 v[56:59], v[36:39], a[152:155], v[56:59]
    v_mfma_f32_16x16x32_bf16 v[60:63], v[36:39], a[156:159], v[60:63]
    v_mfma_f32_16x16x32_bf16 v[80:83], v[40:43], v[40:43], v[80:83]
    v_mfma_f32_16x16x32_bf16 v[48:51], v[40:43], a[160:163], v[48:51]
    v_mfma_f32_16x16x32_bf16 v[52:55], v[40:43], a[164:167], v[52:55]
    v_mfma_f32_16x16x32_bf16 v[56:59], v[40:43], a[168:171], v[56:59]
    v_mfma_f32_16x16x32_bf16 v[60:63], v[40:43], a[172:175], v[60:63]
    v_mfma_f32_16x16x32_bf16 v[80:83], v[44:47], v[44:47], v[80:83]
    v_mfma_f32_16x16x32_bf16 v[48:51], v[44:47], a[176:179], v[48:51]
    v_mfma_f32_16x16x32_bf16 v[52:55], v[44:47], a[180:183], v[52:55]
    v_mfma_f32_16x16x32_bf16 v[56:59], v[44:47], a[184:187], v[56:59]
    v_mfma_f32_16x16x32_bf16 v[60:63], v[44:47], a[188:191], v[60:63]
    s_nop 3
    v_cndmask_b32 v28, v80, v81, s[42:43]
    v_cndmask_b32 v28, v28, v82, s[44:45]
    v_cndmask_b32 v28, v28, v83, s[46:47]
    s_mov_b64 exec, s[48:49]
    ds_write_b32 v15, v28 offset:10240
    s_mov_b64 exec, s[54:55]
    ds_write_b32 v13, v48 offset:0
    ds_write_b32 v13, v52 offset:64
    ds_write_b32 v13, v56 offset:128
    ds_write_b32 v13, v60 offset:192
    ds_write_b32 v13, v49 offset:272
    ds_write_b32 v13, v53 offset:336
    ds_write_b32 v13, v57 offset:400
    ds_write_b32 v13, v61 offset:464
    ds_write_b32 v13, v50 offset:544
    ds_write_b32 v13, v54 offset:608
    ds_write_b32 v13, v58 offset:672
    ds_write_b32 v13, v62 offset:736
    ds_write_b32 v13, v51 offset:816
    ds_write_b32 v13, v55 offset:880
    ds_write_b32 v13, v59 offset:944
    ds_write_b32 v13, v63 offset:1008
    s_mov_b64 exec, -1
    s_waitcnt lgkmcnt(0)
    s_barrier
L_gcj_86:
    ds_read_b128 v[64:67], v10 offset:10240
    ds_read_b128 v[68:71], v10 offset:10256
    v_add_u32 v49, 2560, v9
    v_add_u32 v50, 5120, v9
    v_add_u32 v51, 7680, v9
    ds_read2_b32 v[32:33], v9 offset0:0 offset1:32
    ds_read2_b32 v[34:35], v49 offset0:0 offset1:32
    ds_read2_b32 v[36:37], v50 offset0:0 offset1:32
    ds_read2_b32 v[38:39], v51 offset0:0 offset1:32
    s_cmp_lg_u32 s25, 0
    s_cbranch_scc1 L_csl_87
    v_add_u32 v52, 2176, v23
    v_add_u32 v53, 4736, v23
    v_add_u32 v54, 7296, v23
    v_add_u32 v55, 9856, v23
    ds_read2_b32 v[40:41], v52 offset0:0 offset1:32
    ds_read2_b32 v[42:43], v53 offset0:0 offset1:32
    ds_read2_b32 v[44:45], v54 offset0:0 offset1:32
    ds_read2_b32 v[46:47], v55 offset0:0 offset1:32
    s_waitcnt lgkmcnt(0)
    v_add_f32 v40, v40, v42
    v_add_f32 v44, v44, v46
    v_add_f32 v41, v41, v43
    v_add_f32 v45, v45, v47
    v_add_f32 v40, v40, v44
    v_accvgpr_write_b32 a228, v40
    v_add_f32 v41, v41, v45
    v_accvgpr_write_b32 a229, v41
    s_branch L_csj_88
L_csl_87:
    v_accvgpr_read_b32 v40, a228
    v_accvgpr_read_b32 v41, a229
L_csj_88:
    s_waitcnt lgkmcnt(4)
    v_add_f32 v64, v64, v65
    v_add_f32 v68, v68, v69
    v_add_f32 v66, v66, v67
    v_add_f32 v70, v70, v71
    v_add_f32 v64, v64, v66
    v_add_f32 v68, v68, v70
    v_mul_f32 v72, 0x3b000000, v64
    v_mul_f32 v73, 0x3b000000, v68
    v_fma_f32 v73, -v72, v72, v73
    v_max_f32 v73, 0, v73
    v_add_f32 v73, 0x3727c5ac, v73
    v_rsq_f32 v73, v73
    s_waitcnt lgkmcnt(0)
    v_add_f32 v32, v32, v34
    v_add_f32 v36, v36, v38
    v_add_f32 v33, v33, v35
    v_add_f32 v37, v37, v39
    v_add_f32 v32, v32, v36
    v_add_f32 v33, v33, v37
    v_fma_f32 v32, -v72, v40, v32
    v_fma_f32 v33, -v72, v41, v33
    v_mul_f32 v32, v73, v32
    v_mul_f32 v33, v73, v33
    v_mul_f32 v32, 0xbfb8aa3b, v32
    v_exp_f32 v32, v32
    s_nop 0
    v_add_f32 v32, 1.0, v32
    v_rcp_f32 v32, v32
    s_nop 0
    v_mul_f32 v32, v32, v33
    s_nop 1
    v_mov_b32_dpp v33, v32 quad_perm:[1,0,3,2] row_mask:0xf bank_mask:0xf
    v_cvt_pk_bf16_f32 v28, v32, v33
    s_mov_b64 exec, s[56:57]
    s_cmp_eq_u32 s26, 1
    s_cbranch_scc0 L_nl_89
    buffer_store_dword v28, v11, s[4:7], s38 offen
L_nb_90:
    s_mov_b64 exec, -1
L_roleskip_82:
    s_cmp_lg_u32 s35, 2
    s_cbranch_scc1 L_roleskip_91
B_d:
    s_cmp_lg_u32 s25, 0
    s_cbranch_scc1 L_nodn_92
    s_waitcnt vmcnt(0)
    v_lshrrev_b32 v28, 2, v2
    v_lshl_add_u32 v29, v3, 3, v28
    s_mul_i32 s30, s24, 64
    v_add_u32 v29, s30, v29
    v_lshlrev_b32 v29, 7, v29
    v_lshrrev_b32 v28, 1, v28
    v_and_b32 v30, 1, v3
    v_lshl_add_u32 v28, v30, 1, v28
    v_lshl_add_u32 v29, v28, 5, v29
    v_and_b32 v28, 3, v2
    v_lshl_add_u32 v29, v28, 3, v29
    v_add_u32 v29, 32768, v29
    ds_read_b64_tr_b16 a[192:193], v29 offset:0
    ds_read_b64_tr_b16 a[194:195], v29 offset:512
    ds_read_b64_tr_b16 a[208:209], v29 offset:4096
    ds_read_b64_tr_b16 a[210:211], v29 offset:4608
    v_xor_b32 v28, 32, v29
    ds_read_b64_tr_b16 a[196:197], v28 offset:0
    ds_read_b64_tr_b16 a[198:199], v28 offset:512
    ds_read_b64_tr_b16 a[212:213], v28 offset:4096
    ds_read_b64_tr_b16 a[214:215], v28 offset:4608
    v_xor_b32 v28, 64, v29
    ds_read_b64_tr_b16 a[200:201], v28 offset:0
    ds_read_b64_tr_b16 a[202:203], v28 offset:512
    ds_read_b64_tr_b16 a[216:217], v28 offset:4096
    ds_read_b64_tr_b16 a[218:219], v28 offset:4608
    v_xor_b32 v28, 96, v29
    ds_read_b64_tr_b16 a[204:205], v28 offset:0
    ds_read_b64_tr_b16 a[206:207], v28 offset:512
    ds_read_b64_tr_b16 a[220:221], v28 offset:4096
    ds_read_b64_tr_b16 a[222:223], v28 offset:4608
    s_waitcnt lgkmcnt(0)
L_nodn_92:
    s_cmp_eq_u32 s24, 3
    s_cbranch_scc1 L_d3_93
    s_mov_b32 s28, s27
    s_mov_b64 exec, s[50:51]
L_pd_95:
    buffer_load_dwordx4 v[32:35], v4, s[4:7], s38 offen offset:0 sc1
    buffer_load_dwordx4 v[36:39], v4, s[4:7], s38 offen offset:512 sc1
    s_waitcnt vmcnt(0)
    v_max3_u32 v28, v32, v35, v38
    v_max3_u32 v29, v33, v36, v39
    v_max_u32 v30, v34, v37
    v_max3_u32 v28, v28, v29, v30
    v_cmp_eq_u32 vcc, -1, v28
    s_cbranch_vccz L_pdd_96
    s_sub_u32 s28, s28, 1
    s_cbranch_scc0 L_pd_95
    s_mov_b32 s27, 0
L_pdd_96:
    s_mov_b64 exec, -1
    v_mfma_f32_16x16x32_bf16 v[48:51], v[32:35], a[192:195], 0
    v_mfma_f32_16x16x32_bf16 v[52:55], v[32:35], a[196:199], 0
    v_mfma_f32_16x16x32_bf16 v[56:59], v[32:35], a[200:203], 0
    v_mfma_f32_16x16x32_bf16 v[60:63], v[32:35], a[204:207], 0
    v_mfma_f32_16x16x32_bf16 v[48:51], v[36:39], a[208:211], v[48:51]
    v_mfma_f32_16x16x32_bf16 v[52:55], v[36:39], a[212:215], v[52:55]
    v_mfma_f32_16x16x32_bf16 v[56:59], v[36:39], a[216:219], v[56:59]
    v_mfma_f32_16x16x32_bf16 v[60:63], v[36:39], a[220:223], v[60:63]
    s_branch L_dj_94
L_d3_93:
    s_mov_b32 s28, s27
    s_mov_b64 exec, s[50:51]
L_pd3_97:
    buffer_load_dwordx4 v[32:35], v4, s[4:7], s38 offen offset:0 sc1
    s_waitcnt vmcnt(0)
    v_max3_u32 v28, v32, v33, v34
    v_max_u32 v28, v28, v35
    v_cmp_eq_u32 vcc, -1, v28
    s_cbranch_vccz L_pd3d_98
    s_sub_u32 s28, s28, 1
    s_cbranch_scc0 L_pd3_97
    s_mov_b32 s27, 0
L_pd3d_98:
    s_mov_b64 exec, -1
    v_mfma_f32_16x16x32_bf16 v[48:51], v[32:35], a[192:195], 0
    v_mfma_f32_16x16x32_bf16 v[52:55], v[32:35], a[196:199], 0
    v_mfma_f32_16x16x32_bf16 v[56:59], v[32:35], a[200:203], 0
    v_mfma_f32_16x16x32_bf16 v[60:63], v[32:35], a[204:207], 0
L_dj_94:
    s_mov_b64 exec, s[54:55]
    s_nop 3
    ds_write_b32 v13, v48 offset:0
    ds_write_b32 v13, v52 offset:64
    ds_write_b32 v13, v56 offset:128
    ds_write_b32 v13, v60 offset:192
    ds_write_b32 v13, v49 offset:272
    ds_write_b32 v13, v53 offset:336
    ds_write_b32 v13, v57 offset:400
    ds_write_b32 v13, v61 offset:464
    ds_write_b32 v13, v50 offset:544
    ds_write_b32 v13, v54 offset:608
    ds_write_b32 v13, v58 offset:672
    ds_write_b32 v13, v62 offset:736
    ds_write_b32 v13, v51 offset:816
    ds_write_b32 v13, v55 offset:880
    ds_write_b32 v13, v59 offset:944
    ds_write_b32 v13, v63 offset:1008
    s_mov_b64 exec, -1
    s_waitcnt lgkmcnt(0)
    s_barrier
    s_add_u32 s31, s34, 524288
    s_mov_b64 exec, s[54:55]
    ds_read_b128 v[32:35], v9 offset:0
    ds_read_b128 v[36:39], v9 offset:2560
    ds_read_b128 v[40:43], v9 offset:5120
    ds_read_b128 v[44:47], v9 offset:7680
    s_waitcnt lgkmcnt(0)
    v_pk_add_f32 v[32:33], v[32:33], v[36:37]
    v_pk_add_f32 v[34:35], v[34:35], v[38:39]
    v_pk_add_f32 v[40:41], v[40:41], v[44:45]
    v_pk_add_f32 v[42:43], v[42:43], v[46:47]
    v_pk_add_f32 v[32:33], v[32:33], v[40:41]
    v_pk_add_f32 v[34:35], v[34:35], v[42:43]
    buffer_store_dwordx4 v[32:35], v11, s[4:7], s31 offen sc1
    s_mov_b64 exec, -1
    s_cmp_lg_u32 s24, 0
    s_cbranch_scc1 L_w0skip_99
    s_lshl_b32 s31, s25, 14
    s_lshl_b32 s30, s20, 10
    s_add_u32 s31, s31, s30
    s_lshl_b32 s30, s41, 7
    s_add_u32 s31, s31, s30
    s_add_u32 s31, s31, 1519616
    v_mov_b32 v28, 0
    s_mov_b64 exec, 1
    s_cmp_eq_u32 s26, 1
    s_cbranch_scc0 L_nl_100
    buffer_store_dword v28, v28, s[4:7], s31 offen
L_nb_101:
    s_mov_b64 exec, -1
L_w0skip_99:
L_roleskip_91:
    s_cmp_lg_u32 s24, 0
    s_cbranch_scc1 L_nw0_102
B_z:
    s_cmp_lg_u32 s35, 2
    s_cbranch_scc1 L_sl_105
    s_sleep 10
    s_branch L_slj_104
L_sl_105:
    s_lshr_b32 s29, s21, 2
    s_lshl_b32 s31, s25, 14
    s_lshl_b32 s30, s20, 10
    s_add_u32 s31, s31, s30
    s_lshl_b32 s30, s29, 7
    s_add_u32 s31, s31, s30
    s_add_u32 s31, s31, 1519616
    v_mov_b32 v33, 0
    s_mov_b32 s28, s27
    s_mov_b64 exec, 1
L_cp_106:
    buffer_load_dword v32, v33, s[4:7], s31 offen sc1
    s_waitcnt vmcnt(0)
    v_cmp_eq_u32 vcc, -1, v32
    s_cbranch_vccz L_cd_107
    s_sleep 1
    s_sub_u32 s28, s28, 1
    s_cbranch_scc0 L_cp_106
L_cd_107:
    s_mov_b64 exec, -1
    s_sleep 3
L_slj_104:
    s_mov_b32 s28, s27
L_pr_108:
    buffer_load_dwordx4 v[32:35], v6, s[4:7], s39 offen offset:0 sc1
    buffer_load_dwordx4 v[36:39], v6, s[4:7], s39 offen offset:1024 sc1
    buffer_load_dwordx4 v[40:43], v6, s[4:7], s39 offen offset:2048 sc1
    buffer_load_dwordx4 v[44:47], v6, s[4:7], s39 offen offset:3072 sc1
    s_waitcnt vmcnt(0)
    v_max3_u32 v28, v32, v35, v38
    v_max3_u32 v29, v33, v36, v39
    v_max3_u32 v30, v34, v37, v40
    v_max3_u32 v28, v28, v41, v44
    v_max3_u32 v29, v29, v42, v45
    v_max3_u32 v30, v30, v43, v46
    v_max_u32 v28, v28, v47
    v_max3_u32 v28, v28, v29, v30
    v_cmp_eq_u32 vcc, -1, v28
    s_cbranch_vccz L_prd_109
    s_sub_u32 s28, s28, 1
    s_cbranch_scc0 L_pr_108
    s_mov_b32 s27, 0
L_prd_109:
    v_pk_add_f32 v[32:33], v[32:33], v[36:37]
    v_pk_add_f32 v[34:35], v[34:35], v[38:39]
    v_pk_add_f32 v[40:41], v[40:41], v[44:45]
    v_pk_add_f32 v[42:43], v[42:43], v[46:47]
    v_pk_add_f32 v[32:33], v[32:33], v[40:41]
    v_pk_add_f32 v[34:35], v[34:35], v[42:43]
    v_mov_b32 v36, v32
    v_mov_b32 v37, v33
    v_mov_b32 v38, v34
    v_mov_b32 v39, v35
    v_permlane32_swap_b32 v32, v36
    v_permlane32_swap_b32 v33, v37
    v_permlane32_swap_b32 v34, v38
    v_permlane32_swap_b32 v35, v39
    v_pk_add_f32 v[32:33], v[32:33], v[36:37]
    v_pk_add_f32 v[34:35], v[34:35], v[38:39]
    v_pk_add_f32 v[24:25], v[24:25], v[32:33]
    v_pk_add_f32 v[26:27], v[26:27], v[34:35]
    v_cvt_pk_bf16_f32 v28, v24, v25
    v_cvt_pk_bf16_f32 v29, v26, v27
    s_cmp_eq_u32 s25, 0
    s_cbranch_scc0 L_out
    s_mov_b64 exec, s[54:55]
    s_cmp_eq_u32 s26, 1
    s_cbranch_scc0 L_nl_110
    buffer_store_dwordx2 v[28:29], v7, s[4:7], s40 offen
L_nb_111:
    s_mov_b64 exec, -1
    v_lshlrev_b32 v24, 16, v28
    v_and_b32 v25, 0xffff0000, v28
    v_lshlrev_b32 v26, 16, v29
    v_and_b32 v27, 0xffff0000, v29
    s_branch L_notlast_103
L_nw0_102:
    s_cmp_lg_u32 s25, 0
    s_cbranch_scc1 L_fin
L_notlast_103:
    s_add_u32 s32, s32, 0x10000
B_q:
    s_lshr_b32 s29, s21, 1
    s_and_b32 s29, s29, 3
    s_lshl_b32 s29, s29, 8
    s_and_b32 s30, s21, 1
    s_lshl_b32 s30, s30, 7
    s_add_u32 s29, s29, s30
    s_lshr_b32 s30, s21, 3
    s_lshl_b32 s30, s30, 4
    s_add_u32 s29, s29, s30
    v_bfe_u32 v28, v1, 1, 3
    v_lshlrev_b32 v93, 10, v28
    v_bfe_u32 v28, v1, 4, 1
    v_lshl_add_u32 v93, v28, 6, v93
    v_and_b32 v28, 1, v1
    v_lshl_add_u32 v93, v28, 3, v93
    v_add_u32 v93, s29, v93
    s_lshl_b32 s29, s22, 10
    v_lshlrev_b32 v21, 6, v3
    v_and_b32 v28, 3, v2
    v_lshl_add_u32 v21, v28, 4, v21
    v_add_u32 v21, s29, v21
    v_mov_b32 v32, 0x3f803f80
    v_mov_b32 v33, 0x3f803f80
    v_mov_b32 v34, 0x3f803f80
    v_mov_b32 v35, 0x3f803f80
    v_mov_b32 v36, 0x3f803f80
    v_mov_b32 v37, 0x3f803f80
    v_mov_b32 v38, 0x3f803f80
    v_mov_b32 v39, 0x3f803f80
    v_mov_b32 v40, 0x3f803f80
    v_mov_b32 v41, 0x3f803f80
    v_mov_b32 v42, 0x3f803f80
    v_mov_b32 v43, 0x3f803f80
    v_mov_b32 v44, 0x3f803f80
    v_mov_b32 v45, 0x3f803f80
    v_mov_b32 v46, 0x3f803f80
    v_mov_b32 v47, 0x3f803f80
    s_mov_b32 s28, s27
    s_mov_b64 exec, s[50:51]
L_pa_112:
    buffer_load_dwordx4 v[32:35], v92, s[4:7], s40 offen offset:0 sc1
    buffer_load_dwordx4 v[36:39], v92, s[4:7], s40 offen offset:512 sc1
    buffer_load_dwordx4 v[40:43], v92, s[4:7], s40 offen offset:1024 sc1
    buffer_load_dwordx4 v[44:47], v92, s[4:7], s40 offen offset:1536 sc1
    s_waitcnt vmcnt(0)
    v_max3_u32 v28, v32, v35, v38
    v_max3_u32 v29, v33, v36, v39
    v_max3_u32 v30, v34, v37, v40
    v_max3_u32 v28, v28, v41, v44
    v_max3_u32 v29, v29, v42, v45
    v_max3_u32 v30, v30, v43, v46
    v_max_u32 v28, v28, v47
    v_max3_u32 v28, v28, v29, v30
    v_cmp_eq_u32 vcc, -1, v28
    s_cbranch_vccz L_pad_113
    s_sub_u32 s28, s28, 1
    s_cbranch_scc0 L_pa_112
    s_mov_b32 s27, 0
L_pad_113:
    s_mov_b64 exec, -1
    v_mfma_f32_16x16x32_bf16 v[48:51], v[32:35], a[236:239], 0
    v_mfma_f32_16x16x32_bf16 v[52:55], v[32:35], v[32:35], 0
    v_mfma_f32_16x16x32_bf16 v[48:51], v[36:39], a[240:243], v[48:51]
    v_mfma_f32_16x16x32_bf16 v[52:55], v[36:39], v[36:39], v[52:55]
    v_mfma_f32_16x16x32_bf16 v[48:51], v[40:43], a[244:247], v[48:51]
    v_mfma_f32_16x16x32_bf16 v[52:55], v[40:43], v[40:43], v[52:55]
    v_mfma_f32_16x16x32_bf16 v[48:51], v[44:47], a[248:251], v[48:51]
    v_mfma_f32_16x16x32_bf16 v[52:55], v[44:47], v[44:47], v[52:55]
    s_mov_b64 exec, s[54:55]
    s_nop 5
    ds_write_b32 v13, v48
    ds_write_b32 v13, v49 offset:272
    ds_write_b32 v13, v50 offset:544
    ds_write_b32 v13, v51 offset:816
    s_mov_b64 exec, -1
    v_cndmask_b32 v28, v52, v53, s[42:43]
    v_cndmask_b32 v28, v28, v54, s[44:45]
    v_cndmask_b32 v28, v28, v55, s[46:47]
    s_mov_b64 exec, s[48:49]
    ds_write_b32 v15, v28 offset:10240
    s_mov_b64 exec, -1
    s_waitcnt lgkmcnt(0)
    s_barrier
    s_cmp_lg_u32 s24, 0
    s_cbranch_scc1 L_w0skip_114
B_qe:
    s_mov_b64 exec, s[54:55]
    ds_read_b128 v[68:71], v95 offset:10240
    ds_read_b128 v[72:75], v95 offset:10256
    ds_read_b128 v[32:35], v94 offset:0
    ds_read_b128 v[36:39], v94 offset:2560
    ds_read_b128 v[40:43], v94 offset:5120
    ds_read_b128 v[44:47], v94 offset:7680
    v_accvgpr_read_b32 v48, a232
    v_accvgpr_read_b32 v49, a233
    v_accvgpr_read_b32 v50, a234
    v_accvgpr_read_b32 v51, a235
    s_waitcnt lgkmcnt(4)
    v_add_f32 v68, v68, v69
    v_add_f32 v72, v72, v73
    v_add_f32 v70, v70, v71
    v_add_f32 v74, v74, v75
    v_add_f32 v68, v68, v70
    v_add_f32 v72, v72, v74
    v_mul_f32 v76, 0x3b000000, v68
    v_mul_f32 v77, 0x3b000000, v72
    v_fma_f32 v77, -v76, v76, v77
    v_max_f32 v77, 0, v77
    v_add_f32 v77, 0x3727c5ac, v77
    v_rsq_f32 v77, v77
    s_waitcnt lgkmcnt(0)
    v_pk_add_f32 v[32:33], v[32:33], v[36:37]
    v_pk_add_f32 v[34:35], v[34:35], v[38:39]
    v_pk_add_f32 v[40:41], v[40:41], v[44:45]
    v_pk_add_f32 v[42:43], v[42:43], v[46:47]
    v_pk_add_f32 v[32:33], v[32:33], v[40:41]
    v_pk_add_f32 v[34:35], v[34:35], v[42:43]
    v_fma_f32 v32, -v76, v48, v32
    v_fma_f32 v33, -v76, v49, v33
    v_fma_f32 v34, -v76, v50, v34
    v_fma_f32 v35, -v76, v51, v35
    v_mul_f32 v32, v77, v32
    v_mul_f32 v33, v77, v33
    v_mul_f32 v34, v77, v34
    v_mul_f32 v35, v77, v35
    v_cvt_pk_bf16_f32 v28, v32, v33
    v_cvt_pk_bf16_f32 v29, v34, v35
    s_cmp_eq_u32 s26, 1
    s_cbranch_scc0 L_nl_115
    buffer_store_dwordx2 v[28:29], v93, s[4:7], s32 offen
L_nb_116:
    s_mov_b64 exec, -1
L_w0skip_114:
    s_mov_b32 s25, 1
    s_lshl_b32 s29, s25, 18
    s_lshl_b32 s30, s20, 15
    s_add_u32 s33, s29, s30
    s_add_u32 s33, s33, 131072
    s_lshl_b32 s29, s25, 13
    s_lshl_b32 s30, s20, 10
    s_add_u32 s97, s29, s30
    s_add_u32 s97, s97, 655360
    s_lshl_b32 s29, s25, 17
    s_add_u32 s34, s29, 720896
    s_lshl_b32 s30, s21, 12
    s_add_u32 s29, s29, s30
    s_add_u32 s36, s29, 720896
    s_add_u32 s39, s29, 1245184
    s_lshl_b32 s29, s25, 17
    s_lshl_b32 s30, s20, 13
    s_add_u32 s37, s29, s30
    s_add_u32 s37, s37, 983040
    s_lshl_b32 s29, s25, 15
    s_lshl_b32 s30, s20, 12
    s_add_u32 s38, s29, s30
    s_add_u32 s38, s38, 1179648
B_att:
    s_mov_b32 s28, s27
    s_mov_b64 exec, s[52:53]
L_pq1_117:
    buffer_load_dwordx4 v[64:67], v21, s[4:7], s32 offen offset:0 sc1
    buffer_load_dwordx4 v[68:71], v21, s[4:7], s32 offen offset:256 sc1
    buffer_load_dwordx4 v[72:75], v21, s[4:7], s32 offen offset:512 sc1
    buffer_load_dwordx4 v[76:79], v21, s[4:7], s32 offen offset:768 sc1
    s_waitcnt vmcnt(0)
    v_max3_u32 v28, v64, v67, v70
    v_max3_u32 v29, v65, v68, v71
    v_max3_u32 v30, v66, v69, v72
    v_max3_u32 v28, v28, v73, v76
    v_max3_u32 v29, v29, v74, v77
    v_max3_u32 v30, v30, v75, v78
    v_max_u32 v28, v28, v79
    v_max3_u32 v28, v28, v29, v30
    v_cmp_eq_u32 vcc, -1, v28
    s_cbranch_vccz L_pq1d_118
    s_sub_u32 s28, s28, 1
    s_cbranch_scc0 L_pq1_117
    s_mov_b32 s27, 0
L_pq1d_118:
    s_mov_b64 exec, -1
    v_mfma_f32_16x16x32_bf16 v[32:35], a[0:3], v[64:67], 0
    v_mfma_f32_16x16x32_bf16 v[32:35], a[4:7], v[68:71], v[32:35]
    v_mfma_f32_16x16x32_bf16 v[32:35], a[8:11], v[72:75], v[32:35]
    v_mfma_f32_16x16x32_bf16 v[32:35], a[12:15], v[76:79], v[32:35]
    v_mfma_f32_16x16x32_bf16 v[36:39], a[16:19], v[64:67], 0
    v_mfma_f32_16x16x32_bf16 v[36:39], a[20:23], v[68:71], v[36:39]
    v_mfma_f32_16x16x32_bf16 v[36:39], a[24:27], v[72:75], v[36:39]
    v_mfma_f32_16x16x32_bf16 v[36:39], a[28:31], v[76:79], v[36:39]
    v_mfma_f32_16x16x32_bf16 v[40:43], a[32:35], v[64:67], 0
    v_mfma_f32_16x16x32_bf16 v[40:43], a[36:39], v[68:71], v[40:43]
    v_mfma_f32_16x16x32_bf16 v[40:43], a[40:43], v[72:75], v[40:43]
    v_mfma_f32_16x16x32_bf16 v[40:43], a[44:47], v[76:79], v[40:43]
    v_mfma_f32_16x16x32_bf16 v[44:47], a[48:51], v[64:67], 0
    v_mul_f32_dpp v80, v32, v17 quad_perm:[0,1,2,3] row_mask:0xf bank_mask:0x1
    v_mfma_f32_16x16x32_bf16 v[44:47], a[52:55], v[68:71], v[44:47]
    v_mul_f32_dpp v81, v33, v17 quad_perm:[0,1,2,3] row_mask:0xf bank_mask:0x1
    v_mfma_f32_16x16x32_bf16 v[44:47], a[56:59], v[72:75], v[44:47]
    v_mul_f32_dpp v82, v34, v17 quad_perm:[0,1,2,3] row_mask:0xf bank_mask:0x1
    v_mfma_f32_16x16x32_bf16 v[44:47], a[60:63], v[76:79], v[44:47]
    v_mul_f32_dpp v83, v35, v17 quad_perm:[0,1,2,3] row_mask:0xf bank_mask:0x1
    v_mfma_f32_16x16x32_bf16 v[48:51], a[64:67], v[64:67], 0
    v_mul_f32_dpp v80, v36, v17 row_shr:4 row_mask:0xf bank_mask:0x2
    v_mfma_f32_16x16x32_bf16 v[48:51], a[68:71], v[68:71], v[48:51]
    v_mul_f32_dpp v81, v37, v17 row_shr:4 row_mask:0xf bank_mask:0x2
    v_mfma_f32_16x16x32_bf16 v[48:51], a[72:75], v[72:75], v[48:51]
    v_mul_f32_dpp v82, v38, v17 row_shr:4 row_mask:0xf bank_mask:0x2
    v_mfma_f32_16x16x32_bf16 v[48:51], a[76:79], v[76:79], v[48:51]
    v_mul_f32_dpp v83, v39, v17 row_shr:4 row_mask:0xf bank_mask:0x2
    v_mfma_f32_16x16x32_bf16 v[52:55], a[80:83], v[64:67], 0
    v_mul_f32_dpp v80, v40, v17 row_shr:8 row_mask:0xf bank_mask:0x4
    v_mfma_f32_16x16x32_bf16 v[52:55], a[84:87], v[68:71], v[52:55]
    v_mul_f32_dpp v81, v41, v17 row_shr:8 row_mask:0xf bank_mask:0x4
    v_mfma_f32_16x16x32_bf16 v[52:55], a[88:91], v[72:75], v[52:55]
    v_mul_f32_dpp v82, v42, v17 row_shr:8 row_mask:0xf bank_mask:0x4
    v_mfma_f32_16x16x32_bf16 v[52:55], a[92:95], v[76:79], v[52:55]
    v_mul_f32_dpp v83, v43, v17 row_shr:8 row_mask:0xf bank_mask:0x4
    v_mfma_f32_16x16x32_bf16 v[56:59], a[96:99], v[64:67], 0
    v_mul_f32_dpp v80, v44, v17 row_shr:12 row_mask:0xf bank_mask:0x8
    v_mfma_f32_16x16x32_bf16 v[56:59], a[100:103], v[68:71], v[56:59]
    v_mul_f32_dpp v81, v45, v17 row_shr:12 row_mask:0xf bank_mask:0x8
    v_mfma_f32_16x16x32_bf16 v[56:59], a[104:107], v[72:75], v[56:59]
    v_mul_f32_dpp v82, v46, v17 row_shr:12 row_mask:0xf bank_mask:0x8
    v_mfma_f32_16x16x32_bf16 v[56:59], a[108:111], v[76:79], v[56:59]
    v_mul_f32_dpp v83, v47, v17 row_shr:12 row_mask:0xf bank_mask:0x8
    v_mfma_f32_16x16x32_bf16 v[60:63], a[112:115], v[64:67], 0
    v_mul_f32_dpp v84, v48, v17 quad_perm:[0,1,2,3] row_mask:0xf bank_mask:0x1
    v_mfma_f32_16x16x32_bf16 v[60:63], a[116:119], v[68:71], v[60:63]
    v_mul_f32_dpp v85, v49, v17 quad_perm:[0,1,2,3] row_mask:0xf bank_mask:0x1
    v_mfma_f32_16x16x32_bf16 v[60:63], a[120:123], v[72:75], v[60:63]
    v_mul_f32_dpp v86, v50, v17 quad_perm:[0,1,2,3] row_mask:0xf bank_mask:0x1
    v_mfma_f32_16x16x32_bf16 v[60:63], a[124:127], v[76:79], v[60:63]
    v_mul_f32_dpp v87, v51, v17 quad_perm:[0,1,2,3] row_mask:0xf bank_mask:0x1
    v_mul_f32_dpp v84, v52, v17 row_shr:4 row_mask:0xf bank_mask:0x2
    v_mul_f32_dpp v85, v53, v17 row_shr:4 row_mask:0xf bank_mask:0x2
    v_mul_f32_dpp v86, v54, v17 row_shr:4 row_mask:0xf bank_mask:0x2
    v_mul_f32_dpp v87, v55, v17 row_shr:4 row_mask:0xf bank_mask:0x2
    v_mul_f32_dpp v84, v56, v17 row_shr:8 row_mask:0xf bank_mask:0x4
    v_mul_f32_dpp v85, v57, v17 row_shr:8 row_mask:0xf bank_mask:0x4
    v_mul_f32_dpp v86, v58, v17 row_shr:8 row_mask:0xf bank_mask:0x4
    v_mul_f32_dpp v87, v59, v17 row_shr:8 row_mask:0xf bank_mask:0x4
    v_mul_f32_dpp v84, v60, v17 row_shr:12 row_mask:0xf bank_mask:0x8
    v_mul_f32_dpp v85, v61, v17 row_shr:12 row_mask:0xf bank_mask:0x8
    v_mul_f32_dpp v86, v62, v17 row_shr:12 row_mask:0xf bank_mask:0x8
    v_mul_f32_dpp v87, v63, v17 row_shr:12 row_mask:0xf bank_mask:0x8
    v_max3_f32 v28, v80, v81, v82
    v_max3_f32 v29, v83, v84, v85
    v_max3_f32 v28, v28, v86, v87
    v_max_f32 v28, v28, v29
    s_nop 1
    v_max_f32_dpp v28, v28, v28 row_ror:4 row_mask:0xf bank_mask:0xf
    s_nop 1
    v_max_f32_dpp v28, v28, v28 row_ror:8 row_mask:0xf bank_mask:0xf
    v_mov_b32 v29, v28
    s_nop 1
    v_permlane16_swap_b32 v28, v29
    v_max_f32 v28, v28, v29
    v_mov_b32 v29, v28
    s_nop 1
    v_permlane32_swap_b32 v28, v29
    v_max_f32 v28, v28, v29
    v_pk_add_f32 v[80:81], v[80:81], v[28:29] op_sel_hi:[1,0] neg_lo:[0,1] neg_hi:[0,1]
    v_pk_add_f32 v[82:83], v[82:83], v[28:29] op_sel_hi:[1,0] neg_lo:[0,1] neg_hi:[0,1]
    v_pk_add_f32 v[84:85], v[84:85], v[28:29] op_sel_hi:[1,0] neg_lo:[0,1] neg_hi:[0,1]
    v_pk_add_f32 v[86:87], v[86:87], v[28:29] op_sel_hi:[1,0] neg_lo:[0,1] neg_hi:[0,1]
    v_exp_f32 v80, v80
    v_exp_f32 v81, v81
    v_exp_f32 v82, v82
    v_exp_f32 v83, v83
    v_exp_f32 v84, v84
    v_exp_f32 v85, v85
    v_exp_f32 v86, v86
    v_exp_f32 v87, v87
    v_cvt_pk_bf16_f32 v88, v80, v81
    v_cvt_pk_bf16_f32 v89, v82, v83
    v_cvt_pk_bf16_f32 v90, v84, v85
    v_cvt_pk_bf16_f32 v91, v86, v87
    s_nop 1
    v_mfma_f32_16x16x32_bf16 v[32:35], v[96:99], v[88:91], 0
    v_mov_b32_dpp v68, v88 row_shl:4 row_mask:0xf bank_mask:0xf
    v_mov_b32_dpp v69, v89 row_shl:4 row_mask:0xf bank_mask:0xf
    v_mfma_f32_16x16x32_bf16 v[36:39], v[100:103], v[88:91], 0
    v_mov_b32_dpp v70, v90 row_shl:4 row_mask:0xf bank_mask:0xf
    v_mov_b32_dpp v71, v91 row_shl:4 row_mask:0xf bank_mask:0xf
    v_mfma_f32_16x16x32_bf16 v[40:43], v[104:107], v[88:91], 0
    v_mov_b32_dpp v72, v88 row_shl:8 row_mask:0xf bank_mask:0xf
    v_mov_b32_dpp v73, v89 row_shl:8 row_mask:0xf bank_mask:0xf
    v_mfma_f32_16x16x32_bf16 v[44:47], v[108:111], v[88:91], 0
    v_mov_b32_dpp v74, v90 row_shl:8 row_mask:0xf bank_mask:0xf
    v_mov_b32_dpp v75, v91 row_shl:8 row_mask:0xf bank_mask:0xf
    v_mfma_f32_16x16x32_bf16 v[48:51], v[112:115], v[88:91], 0
    v_mov_b32_dpp v76, v88 row_shl:12 row_mask:0xf bank_mask:0xf
    v_mfma_f32_16x16x32_bf16 v[52:55], v[116:119], v[88:91], 0
    v_mov_b32_dpp v77, v89 row_shl:12 row_mask:0xf bank_mask:0xf
    v_mfma_f32_16x16x32_bf16 v[56:59], v[120:123], v[88:91], 0
    v_mov_b32_dpp v78, v90 row_shl:12 row_mask:0xf bank_mask:0xf
    v_mfma_f32_16x16x32_bf16 v[60:63], v[124:127], v[88:91], 0
    v_mov_b32_dpp v79, v91 row_shl:12 row_mask:0xf bank_mask:0xf
    v_mfma_f32_16x16x32_bf16 v[32:35], v[128:131], v[68:71], v[32:35]
    v_add_f32 v30, v80, v81
    v_mfma_f32_16x16x32_bf16 v[36:39], v[132:135], v[68:71], v[36:39]
    v_add_f32 v29, v82, v83
    v_mfma_f32_16x16x32_bf16 v[40:43], v[136:139], v[68:71], v[40:43]
    v_add_f32 v30, v30, v84
    v_mfma_f32_16x16x32_bf16 v[44:47], v[140:143], v[68:71], v[44:47]
    v_add_f32 v29, v29, v85
    v_mfma_f32_16x16x32_bf16 v[48:51], v[144:147], v[68:71], v[48:51]
    v_add_f32 v30, v30, v86
    v_mfma_f32_16x16x32_bf16 v[52:55], v[148:151], v[68:71], v[52:55]
    v_add_f32 v29, v29, v87
    v_mfma_f32_16x16x32_bf16 v[56:59], v[152:155], v[68:71], v[56:59]
    v_add_f32 v30, v30, v29
    v_mfma_f32_16x16x32_bf16 v[60:63], v[156:159], v[68:71], v[60:63]
    s_nop 0
    v_add_f32_dpp v30, v30, v30 row_ror:4 row_mask:0xf bank_mask:0xf
    v_mfma_f32_16x16x32_bf16 v[32:35], v[160:163], v[72:75], v[32:35]
    s_nop 0
    v_add_f32_dpp v30, v30, v30 row_ror:8 row_mask:0xf bank_mask:0xf
    v_mfma_f32_16x16x32_bf16 v[36:39], v[164:167], v[72:75], v[36:39]
    v_mov_b32 v29, v30
    v_mfma_f32_16x16x32_bf16 v[40:43], v[168:171], v[72:75], v[40:43]
    s_nop 0
    v_permlane16_swap_b32 v30, v29
    v_mfma_f32_16x16x32_bf16 v[44:47], v[172:175], v[72:75], v[44:47]
    v_add_f32 v30, v30, v29
    v_mfma_f32_16x16x32_bf16 v[48:51], v[176:179], v[72:75], v[48:51]
    v_mov_b32 v29, v30
    v_mfma_f32_16x16x32_bf16 v[52:55], v[180:183], v[72:75], v[52:55]
    s_nop 0
    v_permlane32_swap_b32 v30, v29
    v_mfma_f32_16x16x32_bf16 v[56:59], v[184:187], v[72:75], v[56:59]
    v_add_f32 v30, v30, v29
    v_mfma_f32_16x16x32_bf16 v[60:63], v[188:191], v[72:75], v[60:63]
    v_mfma_f32_16x16x32_bf16 v[32:35], v[192:195], v[76:79], v[32:35]
    v_mfma_f32_16x16x32_bf16 v[36:39], v[196:199], v[76:79], v[36:39]
    v_mfma_f32_16x16x32_bf16 v[40:43], v[200:203], v[76:79], v[40:43]
    v_mfma_f32_16x16x32_bf16 v[44:47], v[204:207], v[76:79], v[44:47]
    v_mfma_f32_16x16x32_bf16 v[48:51], v[208:211], v[76:79], v[48:51]
    v_mfma_f32_16x16x32_bf16 v[52:55], v[212:215], v[76:79], v[52:55]
    v_mfma_f32_16x16x32_bf16 v[56:59], v[216:219], v[76:79], v[56:59]
    v_mfma_f32_16x16x32_bf16 v[60:63], v[220:223], v[76:79], v[60:63]
    s_branch L_tail
L_out:
    s_mov_b32 s16, s82
    s_mov_b32 s17, s83
    s_mov_b32 s18, 0x2000
    s_mov_b32 s19, 0x00020000
    v_bfe_u32 v32, v1, 1, 3
    v_cmp_eq_u32 vcc, s20, v32
    s_nop 0
    s_and_b64 exec, vcc, s[54:55]
    buffer_store_dwordx2 v[28:29], v22, s[16:19], 0 offen
    s_mov_b64 exec, -1
L_fin:
    s_waitcnt vmcnt(0)
    s_branch L_end
L_dret:
    s_setpc_b64 s[2:3]
L_end:
    s_endpgm
L_nl_56:
    buffer_store_dword v30, v8, s[4:7], s33 offen sc1
    s_branch L_nb_57
L_nl_58:
    buffer_store_dwordx2 v[28:29], v20, s[4:7], s97 offen sc1
    s_branch L_nb_59
L_nl_71:
    buffer_store_dword v28, v28, s[4:7], s31 offen sc1
    s_branch L_nb_72
L_nl_80:
    buffer_store_dwordx2 v[28:29], v7, s[4:7], s37 offen sc1
    s_branch L_nb_81
L_nl_89:
    buffer_store_dword v28, v11, s[4:7], s38 offen sc1
    s_branch L_nb_90
L_nl_100:
    buffer_store_dword v28, v28, s[4:7], s31 offen sc1
    s_branch L_nb_101
L_nl_110:
    buffer_store_dwordx2 v[28:29], v7, s[4:7], s40 offen sc1
    s_branch L_nb_111
L_nl_115:
    buffer_store_dwordx2 v[28:29], v93, s[4:7], s32 offen sc1
    s_branch L_nb_116
L_code_end:
.section .rodata,"a"
.p2align 6
.amdhsa_kernel interleave_layers__sliding_block_cached__glu_gated_glu__decode_kernel
  .amdhsa_next_free_vgpr 512
  .amdhsa_next_free_sgpr 102
  .amdhsa_accum_offset 256
  .amdhsa_group_segment_fixed_size 0
  .amdhsa_kernarg_size 96
  .amdhsa_user_sgpr_count 2
  .amdhsa_user_sgpr_kernarg_segment_ptr 1
  .amdhsa_system_sgpr_workgroup_id_x 1
  .amdhsa_float_denorm_mode_32 3
.end_amdhsa_kernel
```
